```python
import torch

def _softmax(x, axis=-1):
    return torch.softmax(x, dim=axis)
def _gelu(x):
    return torch.nn.functional.gelu(x, approximate="tanh")
def _silu(x):
    return torch.nn.functional.silu(x)
def _sigmoid(x):
    return torch.sigmoid(x)
def _layernorm(x, axis=-1, eps=1e-5):
    m = x.mean(dim=axis, keepdim=True)
    v = x.var(dim=axis, keepdim=True, unbiased=False)
    return (x - m) / torch.sqrt(v + eps)
def _scatter_add(tgt, idx, src, axis=0):
    return tgt.clone().index_add_(axis, idx, src)
def _segment_sum(src, seg, n):
    out = torch.zeros((n,) + src.shape[1:], dtype=src.dtype)
    return out.index_add_(0, seg, src)
def _pad(x, pw):
    flat = tuple(v for pair in reversed(pw) for v in pair)
    return torch.nn.functional.pad(x, flat)

kernel_name = 'recurrent_scan__gqa_block_cached__geglu_ffn__decode'

def setup_inputs():

    _w = (lambda a: (lambda t: t.to(torch.bfloat16) if t.is_floating_point() else t)(torch.as_tensor(a)))
    def _A_setup():
        B, Sq, D = 2, 1, 640
        Hq, Hkv, Sk, Dh = 32, 32, 4096, 192
        assert Hq % Hkv == 0, (Hq, Hkv)
        return {
            "x": _w((lambda *s: torch.randn(*s, dtype=torch.bfloat16) * 0.05)(B, Sq, D)),
            "k_cache": _w((lambda *s: torch.randn(*s, dtype=torch.bfloat16) * 1.6)(B, Hkv, Sk, Dh)),
            "v_cache": _w((lambda *s: torch.randn(*s, dtype=torch.bfloat16) * 0.2)(B, Hkv, Sk, Dh)),
            "wq": _w((lambda *s: torch.randn(*s, dtype=torch.bfloat16) * 1.6)(D, Hq * Dh) * (D ** -0.5)),
            "wo": _w((lambda *s: torch.randn(*s, dtype=torch.bfloat16) * 0.2)(Hq * Dh, D) * ((Hq * Dh) ** -0.5)),
        }
    _A_in = _A_setup()

    def _B_setup():
        B, S, D, F = 2, 1, 640, 1536
        return {
            "x": _w((lambda *s: torch.randn(*s, dtype=torch.bfloat16) * 0.05)(B, S, D)),
            "w_gate": _w((lambda *s: torch.randn(*s, dtype=torch.bfloat16) * 0.1)(D, F)),
            "w_up": _w((lambda *s: torch.randn(*s, dtype=torch.bfloat16) * 0.1)(D, F)),
            "w_down": _w((lambda *s: torch.randn(*s, dtype=torch.bfloat16) * 0.1)(F, D)),
        }
    _B_in = _B_setup()

    return {
        "A_x": _A_in["x"],
        "A_k_cache": _A_in["k_cache"],
        "A_v_cache": _A_in["v_cache"],
        "A_wq": _A_in["wq"],
        "A_wo": _A_in["wo"],
        "B_x": _B_in["x"],
        "B_w_gate": _B_in["w_gate"],
        "B_w_up": _B_in["w_up"],
        "B_w_down": _B_in["w_down"],
    }

def reference(A_x, A_k_cache, A_v_cache, A_wq, A_wo, B_x, B_w_gate, B_w_up, B_w_down):
    def _A_ref(x, k_cache, v_cache, wq, wo):
        B, Sq, D = x.shape
        Hq, Dh = 32, 192
        Hkv = k_cache.shape[1]
        rep = Hq // Hkv
        q = (lambda x, *d: x.permute(*d))((x @ wq).reshape(B, Sq, Hq, Dh), 0, 2, 1, 3)
        k = (lambda x, n, axis: torch.repeat_interleave(x, n, dim=axis))(k_cache, rep, axis=1)
        v = (lambda x, n, axis: torch.repeat_interleave(x, n, dim=axis))(v_cache, rep, axis=1)
        scores = torch.einsum("bhqd,bhkd->bhqk", q, k) * (Dh ** -0.5)
        p = _softmax(scores, axis=-1)
        o = torch.einsum("bhqk,bhkd->bhqd", p, v)
        return (lambda x, *d: x.permute(*d))(o, 0, 2, 1, 3).reshape(B, Sq, Hq * Dh) @ wo

    def _B_ref(x, w_gate, w_up, w_down):
        return (_gelu(x @ w_gate) * (x @ w_up)) @ w_down

    x = A_x
    xn = _layernorm(x, axis=-1)
    s = _A_ref(xn, A_k_cache, A_v_cache, A_wq, A_wo)
    g = _silu(_B_ref(xn, B_w_gate, B_w_up, B_w_down))
    return x + s * g
```

```asm
; @launch grid=(256,1,1) block=(320,1,1) lds=19456
.amdgcn_target "amdgcn-amd-amdhsa--gfx950"
.text
.globl recurrent_scan__gqa_block_cached__geglu_ffn__decode_kernel
.p2align 8
.type recurrent_scan__gqa_block_cached__geglu_ffn__decode_kernel,@function
recurrent_scan__gqa_block_cached__geglu_ffn__decode_kernel:
    s_cmp_ge_u32 s2, 256
    s_cbranch_scc1 L_end
    s_load_dwordx16 s[4:19], s[0:1], 0
    s_load_dwordx8 s[20:27], s[0:1], 64
    v_lshrrev_b32 v2, 6, v0
    v_and_b32 v1, 63, v0
    v_readfirstlane_b32 s3, v2
    s_lshr_b32 s101, s2, 3
    s_and_b32 s95, s2, 7
    s_and_b32 s66, s101, 3
    s_lshl_b32 s47, s95, 2
    s_add_u32 s66, s66, s47
    s_bfe_u32 s67, s101, 0x10002
    s_lshr_b32 s49, s101, 3
    s_mul_i32 s96, s95, 30
    s_cmp_lg_u32 s3, 0
    s_cbranch_scc1 L_stream
    s_setprio 3
    s_add_u32 s97, s96, s101
    s_mul_i32 s69, s97, 205
    s_lshr_b32 s69, s69, 10
    s_mul_i32 s70, s69, 5
    s_sub_u32 s70, s97, s70
    v_lshrrev_b32 v164, 4, v1
    v_and_b32 v165, 7, v1
    v_bfe_u32 v166, v1, 3, 1
    v_mul_u32_u24 v166, 1280, v166
    v_lshl_add_u32 v167, v164, 3, v165
    v_lshl_add_u32 v160, v167, 4, v166
    v_lshl_add_u32 v161, v167, 3, v166
    s_lshl_b32 s47, s70, 8
    v_add_u32 v161, s47, v161
    v_mul_u32_u24 v2, 393216, v164
    v_and_b32 v165, 15, v1
    v_lshl_add_u32 v2, v165, 4, v2
    s_mul_i32 s62, s70, 1572864
    s_lshl_b32 s48, s69, 8
    s_add_u32 s62, s62, s48
    v_mov_b32 v3, 0
    v_mov_b32 v16, 0
    v_mov_b32 v17, 0
    v_mov_b32 v18, 0
    v_mov_b32 v19, 0
    s_mov_b32 s38, 7864320
    s_mov_b32 s39, 0x20000
    s_waitcnt lgkmcnt(0)
    s_mov_b32 s36, s10
    s_mov_b32 s37, s11
    global_load_dwordx4 v[8:11], v160, s[4:5]
    global_load_dwordx4 v[12:15], v160, s[4:5] offset:512
    global_load_dwordx2 v[20:21], v161, s[4:5]
    s_bfm_b64 exec, 32, 0
    global_load_dwordx4 v[16:19], v160, s[4:5] offset:1024
    s_mov_b64 exec, -1
    s_load_dword s80, s[26:27], 323584
    s_cmp_ge_u32 s101, 30
    s_cbranch_scc1 L_noq1
    buffer_load_dwordx4 v[32:35], v2, s[36:39], s62 offen nt
    s_add_u32 s62, s62, 12288
    buffer_load_dwordx4 v[36:39], v2, s[36:39], s62 offen nt
    s_add_u32 s62, s62, 12288
    buffer_load_dwordx4 v[40:43], v2, s[36:39], s62 offen nt
    s_add_u32 s62, s62, 12288
    buffer_load_dwordx4 v[44:47], v2, s[36:39], s62 offen nt
    s_add_u32 s62, s62, 12288
    buffer_load_dwordx4 v[48:51], v2, s[36:39], s62 offen nt
    s_add_u32 s62, s62, 12288
    buffer_load_dwordx4 v[52:55], v2, s[36:39], s62 offen nt
    s_add_u32 s62, s62, 12288
    buffer_load_dwordx4 v[56:59], v2, s[36:39], s62 offen nt
    s_add_u32 s62, s62, 12288
    buffer_load_dwordx4 v[60:63], v2, s[36:39], s62 offen nt
    s_add_u32 s62, s62, 12288
    buffer_load_dwordx4 v[64:67], v2, s[36:39], s62 offen nt
    s_add_u32 s62, s62, 12288
    buffer_load_dwordx4 v[68:71], v2, s[36:39], s62 offen nt
    s_add_u32 s62, s62, 12288
    buffer_load_dwordx4 v[72:75], v2, s[36:39], s62 offen nt
    s_add_u32 s62, s62, 12288
    buffer_load_dwordx4 v[76:79], v2, s[36:39], s62 offen nt
    s_add_u32 s62, s62, 12288
    buffer_load_dwordx4 v[80:83], v2, s[36:39], s62 offen nt
    s_add_u32 s62, s62, 12288
    buffer_load_dwordx4 v[84:87], v2, s[36:39], s62 offen nt
    s_add_u32 s62, s62, 12288
    buffer_load_dwordx4 v[88:91], v2, s[36:39], s62 offen nt
    s_add_u32 s62, s62, 12288
    buffer_load_dwordx4 v[92:95], v2, s[36:39], s62 offen nt
    s_add_u32 s62, s62, 12288
    buffer_load_dwordx4 v[96:99], v2, s[36:39], s62 offen nt
    s_add_u32 s62, s62, 12288
    buffer_load_dwordx4 v[100:103], v2, s[36:39], s62 offen nt
    s_add_u32 s62, s62, 12288
    buffer_load_dwordx4 v[104:107], v2, s[36:39], s62 offen nt
    s_add_u32 s62, s62, 12288
    buffer_load_dwordx4 v[108:111], v2, s[36:39], s62 offen nt
    s_add_u32 s62, s62, 12288
    buffer_load_dwordx4 v[112:115], v2, s[36:39], s62 offen nt
    s_add_u32 s62, s62, 12288
    buffer_load_dwordx4 v[116:119], v2, s[36:39], s62 offen nt
    s_add_u32 s62, s62, 12288
    buffer_load_dwordx4 v[120:123], v2, s[36:39], s62 offen nt
    s_add_u32 s62, s62, 12288
    buffer_load_dwordx4 v[124:127], v2, s[36:39], s62 offen nt
    s_add_u32 s62, s62, 12288
    buffer_load_dwordx4 v[128:131], v2, s[36:39], s62 offen nt
    s_add_u32 s62, s62, 12288
    buffer_load_dwordx4 v[132:135], v2, s[36:39], s62 offen nt
    s_add_u32 s62, s62, 12288
    buffer_load_dwordx4 v[136:139], v2, s[36:39], s62 offen nt
    s_add_u32 s62, s62, 12288
    buffer_load_dwordx4 v[140:143], v2, s[36:39], s62 offen nt
    s_add_u32 s62, s62, 12288
    buffer_load_dwordx4 v[144:147], v2, s[36:39], s62 offen nt
    s_add_u32 s62, s62, 12288
    buffer_load_dwordx4 v[148:151], v2, s[36:39], s62 offen nt
    s_add_u32 s62, s62, 12288
    buffer_load_dwordx4 v[152:155], v2, s[36:39], s62 offen nt
    s_add_u32 s62, s62, 12288
    buffer_load_dwordx4 v[156:159], v2, s[36:39], s62 offen nt
L_noq1:
    s_barrier
WA_0:
    s_cbranch_execz WA_p1
    v_and_b32 v164, 1, v1
    v_lshlrev_b32 v164, 4, v164
    v_mov_b32 v165, 0xffff
    v_lshlrev_b32 v164, v164, v165
    v_bfe_u32 v165, v1, 1, 2
    v_cmp_eq_u32 s[50:51], 0, v165
    v_cmp_eq_u32 s[52:53], 1, v165
    v_cmp_eq_u32 s[54:55], 2, v165
    v_cmp_eq_u32 s[56:57], 3, v165
    s_nop 0
    v_cndmask_b32 v4, 0, v164, s[50:51]
    v_cndmask_b32 v5, 0, v164, s[52:53]
    v_cndmask_b32 v6, 0, v164, s[54:55]
    v_cndmask_b32 v7, 0, v164, s[56:57]
    s_mov_b32 s81, 4294966784
    s_mov_b32 s64, 0x01000100
    s_mov_b32 s65, 0x03020302
    s_mov_b32 s58, 399999
    s_add_u32 s90, s26, 1572864
    s_addc_u32 s91, s27, 0
    v_mov_b32 v164, 0
    v_mov_b32 v165, 0
    ds_write_b64 v164, v[164:165] offset:896
    s_waitcnt lgkmcnt(0)
    s_add_u32 s82, s80, 1
    s_and_b32 s80, s82, 511
    s_add_u32 s0, s82, 173
    s_and_b32 s0, s0, 511
WA_p1:
    s_cbranch_execz L_wa_ret
    s_add_u32 s1, s82, 346
    s_and_b32 s1, s1, 511
    s_add_u32 s14, s82, 519
    s_and_b32 s14, s14, 511
    s_mov_b32 s84, 1
    s_cmp_ge_u32 s101, 30
    s_cbranch_scc1 L_qgather
    s_mov_b32 s47, 0x3f803f80
    s_waitcnt vmcnt(32)
    v_dot2c_f32_bf16 v164, s47, v8
    v_dot2c_f32_bf16 v164, s47, v9
    v_dot2c_f32_bf16 v164, s47, v10
    v_dot2c_f32_bf16 v164, s47, v11
    v_dot2c_f32_bf16 v164, s47, v12
    v_dot2c_f32_bf16 v164, s47, v13
    v_dot2c_f32_bf16 v164, s47, v14
    v_dot2c_f32_bf16 v164, s47, v15
    v_dot2c_f32_bf16 v164, s47, v16
    v_dot2c_f32_bf16 v164, s47, v17
    v_dot2c_f32_bf16 v164, s47, v18
    v_dot2c_f32_bf16 v164, s47, v19
    s_nop 2
    v_add_f32_dpp v164, v164, v164 quad_perm:[1,0,3,2] row_mask:0xf bank_mask:0xf
    s_nop 1
    v_add_f32_dpp v164, v164, v164 quad_perm:[2,3,0,1] row_mask:0xf bank_mask:0xf
    s_nop 1
    v_add_f32_dpp v164, v164, v164 row_half_mirror row_mask:0xf bank_mask:0xf
    s_nop 1
    v_mov_b32 v167, v164
    s_nop 1
    v_permlane16_swap_b32 v164, v167
    s_nop 0
    v_add_f32 v164, v164, v167
    v_mov_b32 v167, v164
    s_nop 1
    v_permlane32_swap_b32 v164, v167
    s_nop 0
    v_add_f32 v164, v164, v167
    v_mul_f32 v166, 0x3acccccd, v164
WA_1:
    s_cbranch_execz WA_p3
    v_lshlrev_b32 v28, 16, v8
    v_and_b32 v29, 0xffff0000, v8
    v_sub_f32 v28, v28, v166
    v_sub_f32 v29, v29, v166
    v_fmac_f32 v165, v28, v28
    v_fmac_f32 v165, v29, v29
    v_lshlrev_b32 v28, 16, v9
    v_and_b32 v29, 0xffff0000, v9
    v_sub_f32 v28, v28, v166
    v_sub_f32 v29, v29, v166
    v_fmac_f32 v165, v28, v28
    v_fmac_f32 v165, v29, v29
    v_lshlrev_b32 v28, 16, v10
    v_and_b32 v29, 0xffff0000, v10
    v_sub_f32 v28, v28, v166
    v_sub_f32 v29, v29, v166
    v_fmac_f32 v165, v28, v28
    v_fmac_f32 v165, v29, v29
    v_lshlrev_b32 v28, 16, v11
    v_and_b32 v29, 0xffff0000, v11
    v_sub_f32 v28, v28, v166
    v_sub_f32 v29, v29, v166
    v_fmac_f32 v165, v28, v28
    v_fmac_f32 v165, v29, v29
    v_lshlrev_b32 v28, 16, v12
    v_and_b32 v29, 0xffff0000, v12
    v_sub_f32 v28, v28, v166
    v_sub_f32 v29, v29, v166
    v_fmac_f32 v165, v28, v28
    v_fmac_f32 v165, v29, v29
    v_lshlrev_b32 v28, 16, v13
    v_and_b32 v29, 0xffff0000, v13
    v_sub_f32 v28, v28, v166
    v_sub_f32 v29, v29, v166
    v_fmac_f32 v165, v28, v28
    v_fmac_f32 v165, v29, v29
    v_lshlrev_b32 v28, 16, v14
    v_and_b32 v29, 0xffff0000, v14
    v_sub_f32 v28, v28, v166
    v_sub_f32 v29, v29, v166
    v_fmac_f32 v165, v28, v28
WA_p3:
    s_cbranch_execz L_wa_ret
    v_fmac_f32 v165, v29, v29
    v_lshlrev_b32 v28, 16, v15
    v_and_b32 v29, 0xffff0000, v15
    v_sub_f32 v28, v28, v166
    v_sub_f32 v29, v29, v166
    v_fmac_f32 v165, v28, v28
    v_fmac_f32 v165, v29, v29
    s_bfm_b64 exec, 32, 0
    v_lshlrev_b32 v28, 16, v16
    v_and_b32 v29, 0xffff0000, v16
    v_sub_f32 v28, v28, v166
    v_sub_f32 v29, v29, v166
    v_fmac_f32 v165, v28, v28
    v_fmac_f32 v165, v29, v29
    v_lshlrev_b32 v28, 16, v17
    v_and_b32 v29, 0xffff0000, v17
    v_sub_f32 v28, v28, v166
    v_sub_f32 v29, v29, v166
    v_fmac_f32 v165, v28, v28
    v_fmac_f32 v165, v29, v29
    v_lshlrev_b32 v28, 16, v18
    v_and_b32 v29, 0xffff0000, v18
    v_sub_f32 v28, v28, v166
    v_sub_f32 v29, v29, v166
    v_fmac_f32 v165, v28, v28
    v_fmac_f32 v165, v29, v29
    v_lshlrev_b32 v28, 16, v19
    v_and_b32 v29, 0xffff0000, v19
    v_sub_f32 v28, v28, v166
    v_sub_f32 v29, v29, v166
    v_fmac_f32 v165, v28, v28
    v_fmac_f32 v165, v29, v29
    s_mov_b64 exec, -1
    s_nop 1
    v_add_f32_dpp v165, v165, v165 quad_perm:[1,0,3,2] row_mask:0xf bank_mask:0xf
    s_nop 1
    v_add_f32_dpp v165, v165, v165 quad_perm:[2,3,0,1] row_mask:0xf bank_mask:0xf
    s_nop 1
    v_add_f32_dpp v165, v165, v165 row_half_mirror row_mask:0xf bank_mask:0xf
    s_nop 1
WA_2:
    s_cbranch_execz WA_p5
    v_mov_b32 v167, v165
    s_nop 1
    v_permlane16_swap_b32 v165, v167
    s_nop 0
    v_add_f32 v165, v165, v167
    v_mov_b32 v167, v165
    s_nop 1
    v_permlane32_swap_b32 v165, v167
    s_nop 0
    v_add_f32 v165, v165, v167
    v_mul_f32 v165, 0x3acccccd, v165
    v_cvt_pk_bf16_f32 v165, v165, v165
    v_and_b32 v165, 0xffff0000, v165
    v_cvt_pk_bf16_f32 v166, v166, v166
    v_and_b32 v166, 0xffff0000, v166
    v_add_f32 v165, 0x37280000, v165
    v_cvt_pk_bf16_f32 v165, v165, v165
    v_and_b32 v165, 0xffff0000, v165
    v_sqrt_f32 v165, v165
    s_nop 0
    v_cvt_pk_bf16_f32 v165, v165, v165
    v_and_b32 v165, 0xffff0000, v165
    v_rcp_f32 v165, v165
    v_lshlrev_b32 v28, 16, v20
    v_and_b32 v29, 0xffff0000, v20
    v_sub_f32 v28, v28, v166
    v_sub_f32 v29, v29, v166
    v_cvt_pk_bf16_f32 v20, v28, v29
    v_lshlrev_b32 v28, 16, v20
    v_and_b32 v29, 0xffff0000, v20
    v_mul_f32 v28, v28, v165
    v_mul_f32 v29, v29, v165
    v_cvt_pk_bf16_f32 v20, v28, v29
    v_lshlrev_b32 v28, 16, v21
WA_3:
WA_p5:
    s_cbranch_execz L_wa_ret
    v_and_b32 v29, 0xffff0000, v21
    v_sub_f32 v28, v28, v166
    v_sub_f32 v29, v29, v166
    v_cvt_pk_bf16_f32 v21, v28, v29
    v_lshlrev_b32 v28, 16, v21
    v_and_b32 v29, 0xffff0000, v21
    v_mul_f32 v28, v28, v165
    v_mul_f32 v29, v29, v165
    v_cvt_pk_bf16_f32 v21, v28, v29
WQ_0:
    s_cbranch_execz WQ_p1
    v_lshrrev_b32 v164, 4, v1
    v_lshlrev_b32 v164, 6, v164
    v_and_b32 v165, 8, v1
    v_lshl_add_u32 v164, v165, 5, v164
    v_and_b32 v165, 7, v1
    v_lshl_add_u32 v165, v165, 3, v164
    ds_write_b64 v165, v[20:21] offset:0
    s_waitcnt lgkmcnt(0)
    ds_read_b128 v[8:11], v164 offset:0
    ds_read_b128 v[12:15], v164 offset:16
    ds_read_b128 v[16:19], v164 offset:32
    ds_read_b128 v[20:23], v164 offset:48
    v_and_b32 v166, 15, v1
    v_lshlrev_b32 v166, 5, v166
    v_and_b32 v165, 16, v1
    v_add_u32 v166, v166, v165
    v_and_b32 v165, 32, v1
    v_lshl_add_u32 v166, v165, 4, v166
    s_mul_i32 s47, s97, 1280
    v_lshrrev_b32 v3, 2, v166
    v_add_u32 v166, s47, v166
    s_add_u32 s47, s47, 1024
    v_add_u32 v3, s47, v3
    s_mov_b32 s84, 0
    s_waitcnt lgkmcnt(0)
    v_perm_b32 v167, v8, v8, s64
    v_and_b32 v24, v167, v4
    v_and_b32 v25, v167, v5
    v_and_b32 v26, v167, v6
    v_and_b32 v27, v167, v7
    s_waitcnt vmcnt(31)
    s_nop 0
    v_mfma_f32_16x16x32_bf16 v[160:163], v[24:27], v[32:35], 0
    v_perm_b32 v167, v8, v8, s65
    v_and_b32 v28, v167, v4
WQ_p1:
    s_cbranch_execz WQ_p2
    v_and_b32 v29, v167, v5
    v_and_b32 v30, v167, v6
    v_and_b32 v31, v167, v7
    s_waitcnt vmcnt(30)
    s_nop 0
    v_mfma_f32_16x16x32_bf16 v[160:163], v[28:31], v[36:39], v[160:163]
    v_perm_b32 v167, v9, v9, s64
    v_and_b32 v24, v167, v4
    v_and_b32 v25, v167, v5
    v_and_b32 v26, v167, v6
    v_and_b32 v27, v167, v7
    s_waitcnt vmcnt(29)
    s_nop 0
    v_mfma_f32_16x16x32_bf16 v[160:163], v[24:27], v[40:43], v[160:163]
    v_perm_b32 v167, v9, v9, s65
    v_and_b32 v28, v167, v4
    v_and_b32 v29, v167, v5
    v_and_b32 v30, v167, v6
    v_and_b32 v31, v167, v7
    s_waitcnt vmcnt(28)
    s_nop 0
    v_mfma_f32_16x16x32_bf16 v[160:163], v[28:31], v[44:47], v[160:163]
    v_perm_b32 v167, v10, v10, s64
    v_and_b32 v24, v167, v4
    v_and_b32 v25, v167, v5
    v_and_b32 v26, v167, v6
    v_and_b32 v27, v167, v7
    s_waitcnt vmcnt(27)
    s_nop 0
    v_mfma_f32_16x16x32_bf16 v[160:163], v[24:27], v[48:51], v[160:163]
    v_perm_b32 v167, v10, v10, s65
    v_and_b32 v28, v167, v4
    v_and_b32 v29, v167, v5
    v_and_b32 v30, v167, v6
    v_and_b32 v31, v167, v7
    s_waitcnt vmcnt(26)
    s_nop 0
    v_mfma_f32_16x16x32_bf16 v[160:163], v[28:31], v[52:55], v[160:163]
WQ_p2:
    s_cbranch_execz WQ_p3
    v_perm_b32 v167, v11, v11, s64
    v_and_b32 v24, v167, v4
    v_and_b32 v25, v167, v5
    v_and_b32 v26, v167, v6
    v_and_b32 v27, v167, v7
    s_waitcnt vmcnt(25)
    s_nop 0
    v_mfma_f32_16x16x32_bf16 v[160:163], v[24:27], v[56:59], v[160:163]
    v_perm_b32 v167, v11, v11, s65
    v_and_b32 v28, v167, v4
    v_and_b32 v29, v167, v5
    v_and_b32 v30, v167, v6
    v_and_b32 v31, v167, v7
    s_waitcnt vmcnt(24)
    s_nop 0
    v_mfma_f32_16x16x32_bf16 v[160:163], v[28:31], v[60:63], v[160:163]
    v_perm_b32 v167, v12, v12, s64
    v_and_b32 v24, v167, v4
    v_and_b32 v25, v167, v5
    v_and_b32 v26, v167, v6
    v_and_b32 v27, v167, v7
    s_waitcnt vmcnt(23)
    s_nop 0
    v_mfma_f32_16x16x32_bf16 v[160:163], v[24:27], v[64:67], v[160:163]
    v_perm_b32 v167, v12, v12, s65
    v_and_b32 v28, v167, v4
    v_and_b32 v29, v167, v5
    v_and_b32 v30, v167, v6
    v_and_b32 v31, v167, v7
    s_waitcnt vmcnt(22)
    s_nop 0
    v_mfma_f32_16x16x32_bf16 v[160:163], v[28:31], v[68:71], v[160:163]
    v_perm_b32 v167, v13, v13, s64
    v_and_b32 v24, v167, v4
    v_and_b32 v25, v167, v5
    v_and_b32 v26, v167, v6
    v_and_b32 v27, v167, v7
    s_waitcnt vmcnt(21)
    s_nop 0
WQ_p3:
    s_cbranch_execz WQ_p4
    v_mfma_f32_16x16x32_bf16 v[160:163], v[24:27], v[72:75], v[160:163]
    v_perm_b32 v167, v13, v13, s65
    v_and_b32 v28, v167, v4
    v_and_b32 v29, v167, v5
    v_and_b32 v30, v167, v6
    v_and_b32 v31, v167, v7
    s_waitcnt vmcnt(20)
    s_nop 0
    v_mfma_f32_16x16x32_bf16 v[160:163], v[28:31], v[76:79], v[160:163]
    v_perm_b32 v167, v14, v14, s64
    v_and_b32 v24, v167, v4
    v_and_b32 v25, v167, v5
    v_and_b32 v26, v167, v6
    v_and_b32 v27, v167, v7
    s_waitcnt vmcnt(19)
    s_nop 0
    v_mfma_f32_16x16x32_bf16 v[160:163], v[24:27], v[80:83], v[160:163]
    v_perm_b32 v167, v14, v14, s65
    v_and_b32 v28, v167, v4
    v_and_b32 v29, v167, v5
    v_and_b32 v30, v167, v6
    v_and_b32 v31, v167, v7
    s_waitcnt vmcnt(18)
    s_nop 0
    v_mfma_f32_16x16x32_bf16 v[160:163], v[28:31], v[84:87], v[160:163]
    v_perm_b32 v167, v15, v15, s64
    v_and_b32 v24, v167, v4
    v_and_b32 v25, v167, v5
    v_and_b32 v26, v167, v6
    v_and_b32 v27, v167, v7
    s_waitcnt vmcnt(17)
    s_nop 0
    v_mfma_f32_16x16x32_bf16 v[160:163], v[24:27], v[88:91], v[160:163]
    v_perm_b32 v167, v15, v15, s65
    v_and_b32 v28, v167, v4
    v_and_b32 v29, v167, v5
    v_and_b32 v30, v167, v6
    v_and_b32 v31, v167, v7
WQ_p4:
    s_cbranch_execz L_wq_ret
    s_waitcnt vmcnt(16)
    s_nop 0
    v_mfma_f32_16x16x32_bf16 v[160:163], v[28:31], v[92:95], v[160:163]
    v_perm_b32 v167, v16, v16, s64
    v_and_b32 v24, v167, v4
    v_and_b32 v25, v167, v5
    v_and_b32 v26, v167, v6
    v_and_b32 v27, v167, v7
    s_waitcnt vmcnt(15)
    s_nop 0
    v_mfma_f32_16x16x32_bf16 v[160:163], v[24:27], v[96:99], v[160:163]
    v_perm_b32 v167, v16, v16, s65
    v_and_b32 v28, v167, v4
    v_and_b32 v29, v167, v5
    v_and_b32 v30, v167, v6
    v_and_b32 v31, v167, v7
    s_waitcnt vmcnt(14)
    s_nop 0
    v_mfma_f32_16x16x32_bf16 v[160:163], v[28:31], v[100:103], v[160:163]
    v_perm_b32 v167, v17, v17, s64
    v_and_b32 v24, v167, v4
    v_and_b32 v25, v167, v5
    v_and_b32 v26, v167, v6
    v_and_b32 v27, v167, v7
    s_waitcnt vmcnt(13)
    s_nop 0
    v_mfma_f32_16x16x32_bf16 v[160:163], v[24:27], v[104:107], v[160:163]
    v_perm_b32 v167, v17, v17, s65
    v_and_b32 v28, v167, v4
    v_and_b32 v29, v167, v5
    v_and_b32 v30, v167, v6
    v_and_b32 v31, v167, v7
    s_waitcnt vmcnt(12)
    s_nop 0
    v_mfma_f32_16x16x32_bf16 v[160:163], v[28:31], v[108:111], v[160:163]
    v_perm_b32 v167, v18, v18, s64
    v_and_b32 v24, v167, v4
    v_and_b32 v25, v167, v5
WQ_1:
    s_cbranch_execz WQ_p6
    v_and_b32 v26, v167, v6
    v_and_b32 v27, v167, v7
    s_waitcnt vmcnt(11)
    s_nop 0
    v_mfma_f32_16x16x32_bf16 v[160:163], v[24:27], v[112:115], v[160:163]
    v_perm_b32 v167, v18, v18, s65
    v_and_b32 v28, v167, v4
    v_and_b32 v29, v167, v5
    v_and_b32 v30, v167, v6
    v_and_b32 v31, v167, v7
    s_waitcnt vmcnt(10)
    s_nop 0
    v_mfma_f32_16x16x32_bf16 v[160:163], v[28:31], v[116:119], v[160:163]
    v_perm_b32 v167, v19, v19, s64
    v_and_b32 v24, v167, v4
    v_and_b32 v25, v167, v5
    v_and_b32 v26, v167, v6
    v_and_b32 v27, v167, v7
    s_waitcnt vmcnt(9)
    s_nop 0
    v_mfma_f32_16x16x32_bf16 v[160:163], v[24:27], v[120:123], v[160:163]
    v_perm_b32 v167, v19, v19, s65
    v_and_b32 v28, v167, v4
    v_and_b32 v29, v167, v5
    v_and_b32 v30, v167, v6
    v_and_b32 v31, v167, v7
    s_waitcnt vmcnt(8)
    s_nop 0
    v_mfma_f32_16x16x32_bf16 v[160:163], v[28:31], v[124:127], v[160:163]
    v_perm_b32 v167, v20, v20, s64
    v_and_b32 v24, v167, v4
    v_and_b32 v25, v167, v5
    v_and_b32 v26, v167, v6
    v_and_b32 v27, v167, v7
    s_waitcnt vmcnt(7)
    s_nop 0
    v_mfma_f32_16x16x32_bf16 v[160:163], v[24:27], v[128:131], v[160:163]
    v_perm_b32 v167, v20, v20, s65
WQ_p6:
    s_cbranch_execz WQ_p7
    v_and_b32 v28, v167, v4
    v_and_b32 v29, v167, v5
    v_and_b32 v30, v167, v6
    v_and_b32 v31, v167, v7
    s_waitcnt vmcnt(6)
    s_nop 0
    v_mfma_f32_16x16x32_bf16 v[160:163], v[28:31], v[132:135], v[160:163]
    v_perm_b32 v167, v21, v21, s64
    v_and_b32 v24, v167, v4
    v_and_b32 v25, v167, v5
    v_and_b32 v26, v167, v6
    v_and_b32 v27, v167, v7
    s_waitcnt vmcnt(5)
    s_nop 0
    v_mfma_f32_16x16x32_bf16 v[160:163], v[24:27], v[136:139], v[160:163]
    v_perm_b32 v167, v21, v21, s65
    v_and_b32 v28, v167, v4
    v_and_b32 v29, v167, v5
    v_and_b32 v30, v167, v6
    v_and_b32 v31, v167, v7
    s_waitcnt vmcnt(4)
    s_nop 0
    v_mfma_f32_16x16x32_bf16 v[160:163], v[28:31], v[140:143], v[160:163]
    v_perm_b32 v167, v22, v22, s64
    v_and_b32 v24, v167, v4
    v_and_b32 v25, v167, v5
    v_and_b32 v26, v167, v6
    v_and_b32 v27, v167, v7
    s_waitcnt vmcnt(3)
    s_nop 0
    v_mfma_f32_16x16x32_bf16 v[160:163], v[24:27], v[144:147], v[160:163]
    v_perm_b32 v167, v22, v22, s65
    v_and_b32 v28, v167, v4
    v_and_b32 v29, v167, v5
    v_and_b32 v30, v167, v6
    v_and_b32 v31, v167, v7
    s_waitcnt vmcnt(2)
    s_nop 0
    v_mfma_f32_16x16x32_bf16 v[160:163], v[28:31], v[148:151], v[160:163]
WQ_p7:
    s_cbranch_execz WQ_p8
    v_perm_b32 v167, v23, v23, s64
    v_and_b32 v24, v167, v4
    v_and_b32 v25, v167, v5
    v_and_b32 v26, v167, v6
    v_and_b32 v27, v167, v7
    s_waitcnt vmcnt(1)
    s_nop 0
    v_mfma_f32_16x16x32_bf16 v[160:163], v[24:27], v[152:155], v[160:163]
    v_perm_b32 v167, v23, v23, s65
    v_and_b32 v28, v167, v4
    v_and_b32 v29, v167, v5
    v_and_b32 v30, v167, v6
    v_and_b32 v31, v167, v7
    s_waitcnt vmcnt(0)
    s_nop 0
    v_mfma_f32_16x16x32_bf16 v[160:163], v[28:31], v[156:159], v[160:163]
    s_nop 7
    global_store_dwordx4 v166, v[160:163], s[26:27]
    v_xor_b32 v165, v160, v161
    v_xor_b32 v167, v162, v163
    v_xor_b32 v165, s82, v165
    v_xor_b32 v165, v165, v167
    global_store_dword v3, v165, s[26:27]
L_qgather:
    s_mul_i32 s47, s66, 192
    v_lshl_add_u32 v164, v1, 2, s47
    v_lshrrev_b32 v167, 7, v164
    v_mul_u32_u24 v167, 6400, v167
    v_and_b32 v164, 127, v164
    s_lshl_b32 s47, s67, 7
    s_add_u32 s47, s47, 3584
    v_add3_u32 v2, v167, v164, s47
    v_lshl_add_u32 v167, v164, 2, v167
    s_lshl_b32 s47, s67, 9
    s_add_u32 s47, s47, 2560
WQ_p8:
    s_cbranch_execz WQ_p9
    v_add_u32 v167, s47, v167
    s_bfm_b64 s[86:87], 48, 0
    s_mov_b64 s[88:89], s[86:87]
    s_mov_b64 s[98:99], s[86:87]
    s_mov_b64 s[76:77], s[86:87]
    s_mov_b64 s[74:75], s[86:87]
    s_mov_b64 s[92:93], s[26:27]
L_pollQ:
    s_mov_b64 exec, s[86:87]
    s_cbranch_execz L_pq_1
    global_load_dwordx4 v[32:35], v167, s[92:93] offset:-2560 sc1
    global_load_dword v52, v2, s[92:93] offset:-2560 sc1
L_pq_1:
    s_mov_b64 exec, s[88:89]
    s_cbranch_execz L_pq_2
    global_load_dwordx4 v[36:39], v167, s[92:93] offset:-1280 sc1
    global_load_dword v53, v2, s[92:93] offset:-1280 sc1
L_pq_2:
    s_mov_b64 exec, s[98:99]
    s_cbranch_execz L_pq_3
    global_load_dwordx4 v[40:43], v167, s[92:93] offset:0 sc1
    global_load_dword v54, v2, s[92:93] offset:0 sc1
L_pq_3:
    s_mov_b64 exec, s[76:77]
    s_cbranch_execz L_pq_4
    global_load_dwordx4 v[44:47], v167, s[92:93] offset:1280 sc1
    global_load_dword v55, v2, s[92:93] offset:1280 sc1
L_pq_4:
    s_mov_b64 exec, s[74:75]
    s_cbranch_execz L_pq_5
    global_load_dwordx4 v[48:51], v167, s[92:93] offset:2560 sc1
    global_load_dword v56, v2, s[92:93] offset:2560 sc1
L_pq_5:
    s_cmp_lg_u32 s84, 0
    s_cbranch_scc1 L_pq_w0
    s_mov_b32 s84, 1
    s_mov_b64 exec, -1
    global_store_dwordx4 v166, v[160:163], s[90:91] sc1
    global_store_dword v3, v165, s[90:91] sc1
    s_waitcnt vmcnt(2)
    s_branch L_pq_w1
L_pq_w0:
    s_waitcnt vmcnt(0)
L_pq_w1:
    s_mov_b64 exec, -1
WQ_p9:
    s_cbranch_execz L_wq_ret
    s_nop 0
    s_mov_b64 exec, s[86:87]
    v_xor_b32 v164, v32, v33
    v_xor_b32 v52, v52, v34
    v_xor_b32 v164, v164, v35
    v_xor_b32 v164, v164, v52
    v_cmp_ne_u32 vcc, s82, v164
    s_mov_b64 s[86:87], vcc
    s_mov_b64 exec, s[88:89]
    v_xor_b32 v164, v36, v37
    v_xor_b32 v53, v53, v38
    v_xor_b32 v164, v164, v39
    v_xor_b32 v164, v164, v53
    v_cmp_ne_u32 vcc, s82, v164
    s_mov_b64 s[88:89], vcc
    s_mov_b64 exec, s[98:99]
    v_xor_b32 v164, v40, v41
    v_xor_b32 v54, v54, v42
    v_xor_b32 v164, v164, v43
    v_xor_b32 v164, v164, v54
    v_cmp_ne_u32 vcc, s82, v164
    s_mov_b64 s[98:99], vcc
    s_mov_b64 exec, s[76:77]
    v_xor_b32 v164, v44, v45
    v_xor_b32 v55, v55, v46
    v_xor_b32 v164, v164, v47
    v_xor_b32 v164, v164, v55
    v_cmp_ne_u32 vcc, s82, v164
    s_mov_b64 s[76:77], vcc
    s_mov_b64 exec, s[74:75]
    v_xor_b32 v164, v48, v49
    v_xor_b32 v56, v56, v50
    v_xor_b32 v164, v164, v51
    v_xor_b32 v164, v164, v56
    v_cmp_ne_u32 vcc, s82, v164
    s_mov_b64 s[74:75], vcc
    s_or_b64 s[50:51], s[86:87], s[88:89]
    s_or_b64 s[52:53], s[98:99], s[76:77]
    s_or_b64 s[50:51], s[50:51], s[74:75]
    s_or_b64 s[50:51], s[50:51], s[52:53]
    s_cbranch_scc0 L_gotQ
    s_and_b32 s47, s58, 7
    s_cmp_eq_u32 s47, 0
    s_cselect_b64 s[92:93], s[90:91], s[26:27]
    s_sub_u32 s58, s58, 1
    s_cmp_gt_i32 s58, 0
    s_cbranch_scc1 L_pollQ
L_gotQ:
    s_bfm_b64 exec, 48, 0
WQ_2:
    s_cbranch_execz WQ_p11
    s_cmp_eq_u32 s92, s26
    s_cselect_b32 s47, 63, 0
    v_mov_b32 v165, s47
    v_mov_b32 v164, 0
    ds_write_b32 v164, v165 offset:900
    v_lshlrev_b32 v164, 3, v1
    v_add_f32 v32, v32, v36
    v_add_f32 v33, v33, v37
    v_add_f32 v34, v34, v38
    v_add_f32 v35, v35, v39
    v_add_f32 v32, v32, v40
    v_add_f32 v33, v33, v41
    v_add_f32 v34, v34, v42
    v_add_f32 v35, v35, v43
    v_add_f32 v32, v32, v44
    v_add_f32 v33, v33, v45
    v_add_f32 v34, v34, v46
    v_add_f32 v35, v35, v47
    v_add_f32 v32, v32, v48
    v_add_f32 v33, v33, v49
    v_add_f32 v34, v34, v50
    v_add_f32 v35, v35, v51
    v_cvt_pk_bf16_f32 v32, v32, v33
    v_cvt_pk_bf16_f32 v33, v34, v35
    ds_write_b64 v164, v[32:33] offset:512
    s_mov_b64 exec, -1
    s_waitcnt lgkmcnt(0)
    s_barrier
    s_branch L_aux2
WQ_p11:
    s_cbranch_execz WQ_p12
L_stream:
    s_sub_u32 s3, s3, 1
    s_lshl_b32 s42, s49, 2
    s_add_u32 s42, s42, s3
    s_lshl_b32 s40, s67, 5
    s_add_u32 s40, s40, s66
    s_mul_i32 s94, s40, 97
    s_mul_i32 s40, s40, 1572864
    v_lshrrev_b32 v2, 3, v1
    v_mul_u32_u24 v2, 384, v2
    v_and_b32 v3, 7, v1
    v_lshl_add_u32 v2, v3, 4, v2
    s_add_u32 s48, s42, s94
    s_and_b32 s48, s48, 255
    s_mul_i32 s48, s48, 6144
    s_add_u32 s44, s40, s48
    s_add_u32 s47, s42, 4
    s_and_b32 s47, s47, 15
    s_add_u32 s47, s47, 16
    s_add_u32 s48, s47, s94
    s_and_b32 s48, s48, 255
    s_mul_i32 s48, s48, 6144
    s_add_u32 s43, s40, s48
    s_mov_b32 s30, 100663296
    s_mov_b32 s31, 0x20000
    s_mov_b32 s34, 100663296
    s_mov_b32 s35, 0x20000
    s_mov_b64 exec, 0
    s_cmp_eq_u32 s3, 0
    s_cbranch_scc1 WA_0
    s_cmp_eq_u32 s3, 1
    s_cbranch_scc1 WA_1
    s_cmp_eq_u32 s3, 2
    s_cbranch_scc1 WA_2
    s_branch WA_3
L_wa_ret:
    s_mov_b64 exec, -1
    s_waitcnt lgkmcnt(0)
WQ_p12:
    s_cbranch_execz WQ_p13
    s_mov_b32 s28, s6
    s_mov_b32 s29, s7
    s_mov_b32 s32, s8
    s_mov_b32 s33, s9
    s_setprio 1
    s_barrier
    buffer_load_dwordx4 v[96:99], v2, s[28:31], s44 offen offset:0 nt
    buffer_load_dwordx4 v[100:103], v2, s[28:31], s44 offen offset:128 nt
    buffer_load_dwordx4 v[104:107], v2, s[28:31], s44 offen offset:256 nt
    buffer_load_dwordx4 v[108:111], v2, s[28:31], s44 offen offset:3072 nt
    buffer_load_dwordx4 v[112:115], v2, s[28:31], s44 offen offset:3200 nt
    buffer_load_dwordx4 v[116:119], v2, s[28:31], s44 offen offset:3328 nt
WQ_p13:
    s_cbranch_execz WQ_p14
    s_mov_b64 exec, 0
    s_cmp_eq_u32 s3, 0
    s_cbranch_scc1 WQ_0
    s_cmp_eq_u32 s3, 1
    s_cbranch_scc1 WQ_1
    s_cmp_eq_u32 s3, 2
    s_cbranch_scc1 WQ_2
    s_branch WQ_3
L_wq_ret:
    s_mov_b64 exec, -1
    s_load_dword s80, s[26:27], 323584
    v_and_b32 v42, 1, v1
    v_lshlrev_b32 v42, 4, v42
    v_mov_b32 v46, 0xffff
    v_lshlrev_b32 v42, v42, v46
    v_bfe_u32 v46, v1, 1, 2
    v_cmp_eq_u32 s[50:51], 0, v46
    v_cmp_eq_u32 s[52:53], 1, v46
    v_cmp_eq_u32 s[54:55], 2, v46
    v_cmp_eq_u32 s[56:57], 3, v46
    s_nop 0
    v_cndmask_b32 v4, 0, v42, s[50:51]
    v_cndmask_b32 v5, 0, v42, s[52:53]
    v_cndmask_b32 v6, 0, v42, s[54:55]
    v_cndmask_b32 v7, 0, v42, s[56:57]
    s_add_u32 s98, s101, 17
    s_and_b32 s98, s98, 31
    s_cmp_ge_u32 s98, 30
    s_cselect_b32 s83, 1, 0
    s_add_u32 s98, s98, s96
    s_mul_i32 s69, s98, 205
    s_lshr_b32 s69, s69, 10
    s_mul_i32 s70, s69, 5
    s_sub_u32 s70, s98, s70
    s_mov_b32 s36, s12
    s_mov_b32 s37, s13
WQ_p14:
    s_cbranch_execz L_wq_ret
    s_mov_b32 s38, 7864320
    s_mov_b32 s39, 0x20000
    s_lshl_b32 s71, s69, 2
    s_add_u32 s71, s71, s3
    s_mul_i32 s72, s71, 40960
    s_lshl_b32 s47, s70, 8
    s_add_u32 s72, s72, s47
    s_add_u32 s73, s72, 5120
    v_lshrrev_b32 v3, 4, v1
    v_mul_u32_u24 v3, 10240, v3
    v_and_b32 v42, 15, v1
    v_lshl_add_u32 v3, v42, 4, v3
    s_lshl_b32 s47, s83, 30
    v_add_u32 v3, s47, v3
    s_mov_b32 s41, 2
    s_mov_b32 s46, 1069066811
    s_mov_b32 s58, 399999
    s_add_u32 s90, s26, 1572864
    s_addc_u32 s91, s27, 0
    s_mov_b64 s[92:93], s[26:27]
    s_waitcnt vmcnt(3)
    buffer_load_dwordx4 v[120:123], v2, s[32:35], s44 offen offset:0 nt
    buffer_load_dwordx4 v[124:127], v2, s[32:35], s44 offen offset:128 nt
    buffer_load_dwordx4 v[128:131], v2, s[32:35], s44 offen offset:256 nt
    v_mov_b32 v20, 0
    v_mov_b32 v21, 0
    v_mov_b32 v22, 0
    v_mov_b32 v23, 0
    v_mov_b32 v24, 0
    v_mov_b32 v25, 0
    v_mov_b32 v26, 0
    v_mov_b32 v27, 0
    v_mov_b32 v28, 0
    v_mov_b32 v29, 0
    v_mov_b32 v30, 0
    v_mov_b32 v31, 0
WQ_3:
    s_cbranch_execz WQ_p16
    v_mov_b32 v43, 0xff800000
    v_mov_b32 v44, 0xff800000
    v_mov_b32 v45, 0
    v_mov_b32 v145, 0x7ff00000
    v_mov_b32 v146, 0
    s_mul_i32 s47, s71, 171
    s_lshr_b32 s47, s47, 10
    s_mul_i32 s48, s47, 6
    s_sub_u32 s48, s71, s48
    s_lshl_b32 s47, s47, 13
    s_add_u32 s47, s47, 327680
    v_and_b32 v149, 7, v1
    v_lshl_add_u32 v149, v149, 10, s47
    v_lshrrev_b32 v148, 3, v1
    s_lshl_b32 s48, s48, 7
    v_lshl_add_u32 v148, v148, 4, s48
    v_add_u32 v148, v148, v149
    v_lshrrev_b32 v150, 4, v1
    v_lshlrev_b32 v150, 6, v150
    v_and_b32 v151, 8, v1
    v_lshl_add_u32 v150, v151, 1, v150
    v_add_u32 v151, 32, v150
    s_mul_i32 s47, s3, 3072
    v_lshl_add_u32 v152, v1, 4, s47
    s_lshl_b32 s47, s3, 3
    v_mov_b32 v153, s47
    s_lshl_b32 s47, s3, 10
    v_lshl_add_u32 v154, v1, 4, s47
    s_waitcnt vmcnt(3)
    buffer_load_dwordx4 v[132:135], v2, s[32:35], s44 offen offset:3072 nt
    buffer_load_dwordx4 v[136:139], v2, s[32:35], s44 offen offset:3200 nt
    buffer_load_dwordx4 v[140:143], v2, s[32:35], s44 offen offset:3328 nt
WQ_p16:
    s_cbranch_execz WQ_p17
    s_mov_b64 exec, 0
    s_cmp_eq_u32 s3, 0
    s_cbranch_scc1 WS_0
    s_cmp_eq_u32 s3, 1
    s_cbranch_scc1 WS_1
    s_cmp_eq_u32 s3, 2
    s_cbranch_scc1 WS_2
    s_branch WS_3
L_ws_ret:
    s_mov_b64 exec, -1
    s_waitcnt vmcnt(3)
    buffer_load_dwordx4 v[48:51], v2, s[28:31], s43 offen offset:0 nt
    buffer_load_dwordx4 v[52:55], v2, s[28:31], s43 offen offset:128 nt
    buffer_load_dwordx4 v[56:59], v2, s[28:31], s43 offen offset:256 nt
    s_waitcnt vmcnt(3)
    buffer_load_dwordx4 v[60:63], v2, s[28:31], s43 offen offset:3072 nt
    buffer_load_dwordx4 v[64:67], v2, s[28:31], s43 offen offset:3200 nt
    buffer_load_dwordx4 v[68:71], v2, s[28:31], s43 offen offset:3328 nt
    s_waitcnt vmcnt(3)
    buffer_load_dwordx4 v[72:75], v2, s[32:35], s43 offen offset:0 nt
    buffer_load_dwordx4 v[76:79], v2, s[32:35], s43 offen offset:128 nt
    buffer_load_dwordx4 v[80:83], v2, s[32:35], s43 offen offset:256 nt
    s_waitcnt vmcnt(3)
    buffer_load_dwordx4 v[84:87], v2, s[32:35], s43 offen offset:3072 nt
    buffer_load_dwordx4 v[88:91], v2, s[32:35], s43 offen offset:3200 nt
    buffer_load_dwordx4 v[92:95], v2, s[32:35], s43 offen offset:3328 nt
    s_add_u32 s85, s42, 8
    s_and_b32 s85, s85, 15
    s_add_u32 s85, s85, 32
    s_add_u32 s48, s85, s94
    s_and_b32 s48, s48, 255
    s_mul_i32 s48, s48, 6144
    s_add_u32 s99, s40, s48
    s_waitcnt vmcnt(3)
WQ_p17:
    s_cbranch_execz L_wq_ret
    buffer_load_dwordx4 v[156:159], v2, s[28:31], s99 offen offset:0 nt
    buffer_load_dwordx4 v[160:163], v2, s[28:31], s99 offen offset:128 nt
    buffer_load_dwordx4 v[164:167], v2, s[28:31], s99 offen offset:256 nt
    s_add_u32 s47, s42, 12
    s_and_b32 s47, s47, 15
    s_add_u32 s47, s47, 240
    s_add_u32 s48, s47, s94
    s_and_b32 s48, s48, 255
    s_mul_i32 s48, s48, 6144
    s_add_u32 s44, s40, s48
    s_mov_b32 s45, 0
    v_and_b32 v42, 7, v1
    v_lshlrev_b32 v42, 4, v42
    s_waitcnt lgkmcnt(0)
    s_add_u32 s82, s80, 1
    s_and_b32 s80, s82, 511
    s_add_u32 s0, s82, 173
    s_and_b32 s0, s0, 511
    s_add_u32 s1, s82, 346
    s_and_b32 s1, s1, 511
    s_add_u32 s14, s82, 519
    s_and_b32 s14, s14, 511
    s_barrier
    ds_read_b128 v[8:11], v42 offset:512
    ds_read_b128 v[12:15], v42 offset:640
    ds_read_b128 v[16:19], v42 offset:768
    ds_read_b32 v46, v146 offset:900
    s_waitcnt lgkmcnt(0)
    v_readfirstlane_b32 s89, v46
WS_0:
    s_cbranch_execz WS_p1
    v_mov_b32 v40, 0
    v_mov_b32 v41, 0
    s_add_u32 s48, s85, s94
    s_and_b32 s48, s48, 255
    s_mul_i32 s48, s48, 6144
    s_add_u32 s43, s40, s48
    s_waitcnt vmcnt(12)
    v_dot2c_f32_bf16 v40, v48, v8
    v_dot2c_f32_bf16 v40, v49, v9
    v_dot2c_f32_bf16 v40, v50, v10
    v_dot2c_f32_bf16 v40, v51, v11
    v_dot2c_f32_bf16 v40, v52, v12
    v_dot2c_f32_bf16 v40, v53, v13
    v_dot2c_f32_bf16 v40, v54, v14
    v_dot2c_f32_bf16 v40, v55, v15
    v_dot2c_f32_bf16 v40, v56, v16
    v_dot2c_f32_bf16 v40, v57, v17
    v_dot2c_f32_bf16 v40, v58, v18
    v_dot2c_f32_bf16 v40, v59, v19
    s_waitcnt vmcnt(9)
    v_dot2c_f32_bf16 v41, v60, v8
    v_dot2c_f32_bf16 v41, v61, v9
    v_dot2c_f32_bf16 v41, v62, v10
    v_dot2c_f32_bf16 v41, v63, v11
    v_dot2c_f32_bf16 v41, v64, v12
    v_dot2c_f32_bf16 v41, v65, v13
    v_dot2c_f32_bf16 v41, v66, v14
    v_dot2c_f32_bf16 v41, v67, v15
    v_dot2c_f32_bf16 v41, v68, v16
    v_dot2c_f32_bf16 v41, v69, v17
    v_dot2c_f32_bf16 v41, v70, v18
    v_dot2c_f32_bf16 v41, v71, v19
    buffer_load_dwordx4 v[60:63], v2, s[28:31], s43 offen offset:3072 nt
    buffer_load_dwordx4 v[64:67], v2, s[28:31], s43 offen offset:3200 nt
    buffer_load_dwordx4 v[68:71], v2, s[28:31], s43 offen offset:3328 nt
    s_add_u32 s48, s85, 4
    s_and_b32 s48, s48, 15
    s_andn2_b32 s85, s85, 15
    s_add_u32 s85, s85, s48
    s_add_u32 s85, s85, 16
    v_add_f32_dpp v40, v40, v40 quad_perm:[1,0,3,2] row_mask:0xf bank_mask:0xf
WS_p1:
    s_cbranch_execz WS_p2
    v_add_f32_dpp v41, v41, v41 quad_perm:[1,0,3,2] row_mask:0xf bank_mask:0xf
    s_nop 0
    v_add_f32_dpp v40, v40, v40 quad_perm:[2,3,0,1] row_mask:0xf bank_mask:0xf
    v_add_f32_dpp v41, v41, v41 quad_perm:[2,3,0,1] row_mask:0xf bank_mask:0xf
    s_nop 0
    v_add_f32_dpp v40, v40, v40 row_half_mirror row_mask:0xf bank_mask:0xf
    v_add_f32_dpp v41, v41, v41 row_half_mirror row_mask:0xf bank_mask:0xf
    s_nop 0
    v_cvt_pk_bf16_f32 v42, v40, v41
    v_lshlrev_b32 v40, 16, v42
    v_and_b32 v41, 0xffff0000, v42
    v_mul_f32 v40, 1033096506, v40
    v_mul_f32 v41, 1033096506, v41
    v_cvt_pk_bf16_f32 v42, v40, v41
    v_lshlrev_b32 v40, 16, v42
    v_and_b32 v41, 0xffff0000, v42
    v_max_f32 v42, v40, v41
    v_cmp_gt_f32 vcc, v42, v43
    s_cbranch_vccz L_skip_6
    v_max_f32_dpp v42, v42, v42 row_ror:8 row_mask:0xf bank_mask:0xf
    v_mov_b32 v46, v42
    s_nop 1
    v_permlane16_swap_b32 v42, v46
    s_nop 0
    v_max_f32 v42, v42, v46
    v_mov_b32 v46, v42
    s_nop 1
    v_permlane32_swap_b32 v42, v46
    s_nop 0
    v_max_f32 v42, v42, v46
    v_max_f32 v43, v43, v42
    v_mul_f32 v46, s46, v43
    v_sub_f32 v47, v44, v46
    v_exp_f32 v47, v47
    v_mov_b32 v44, v46
    v_mul_f32 v45, v45, v47
WS_p2:
    s_cbranch_execz WS_p3
    v_mul_f32 v20, v20, v47
    v_mul_f32 v21, v21, v47
    v_mul_f32 v22, v22, v47
    v_mul_f32 v23, v23, v47
    v_mul_f32 v24, v24, v47
    v_mul_f32 v25, v25, v47
    v_mul_f32 v26, v26, v47
    v_mul_f32 v27, v27, v47
    v_mul_f32 v28, v28, v47
    v_mul_f32 v29, v29, v47
    v_mul_f32 v30, v30, v47
    v_mul_f32 v31, v31, v47
L_skip_6:
    v_fma_f32 v46, v40, s46, -v44
    v_fma_f32 v47, v41, s46, -v44
    v_exp_f32 v46, v46
    v_exp_f32 v47, v47
    s_nop 0
    v_add_f32 v45, v45, v46
    v_cvt_pk_bf16_f32 v46, v46, v46
    v_add_f32 v45, v45, v47
    v_cvt_pk_bf16_f32 v47, v47, v47
    v_and_b32 v32, v46, v4
    v_and_b32 v33, v46, v5
    v_and_b32 v34, v46, v6
    v_and_b32 v35, v46, v7
    v_and_b32 v36, v47, v4
    v_and_b32 v37, v47, v5
    v_and_b32 v38, v47, v6
    v_and_b32 v39, v47, v7
    s_waitcnt vmcnt(9)
    v_mfma_f32_16x16x32_bf16 v[20:23], v[32:35], v[72:75], v[20:23]
    v_mfma_f32_16x16x32_bf16 v[24:27], v[32:35], v[76:79], v[24:27]
    v_mfma_f32_16x16x32_bf16 v[28:31], v[32:35], v[80:83], v[28:31]
    s_waitcnt vmcnt(6)
    v_mfma_f32_16x16x32_bf16 v[20:23], v[36:39], v[84:87], v[20:23]
    v_mfma_f32_16x16x32_bf16 v[24:27], v[36:39], v[88:91], v[24:27]
    v_mfma_f32_16x16x32_bf16 v[28:31], v[36:39], v[92:95], v[28:31]
L_F:
    v_mov_b32 v40, 0
WS_p3:
    s_cbranch_execz L_ws_ret
    v_mov_b32 v41, 0
    s_waitcnt vmcnt(15)
    v_dot2c_f32_bf16 v40, v96, v8
    v_dot2c_f32_bf16 v40, v97, v9
    v_dot2c_f32_bf16 v40, v98, v10
    v_dot2c_f32_bf16 v40, v99, v11
    v_dot2c_f32_bf16 v40, v100, v12
    v_dot2c_f32_bf16 v40, v101, v13
    v_dot2c_f32_bf16 v40, v102, v14
    v_dot2c_f32_bf16 v40, v103, v15
    v_dot2c_f32_bf16 v40, v104, v16
    v_dot2c_f32_bf16 v40, v105, v17
    v_dot2c_f32_bf16 v40, v106, v18
    v_dot2c_f32_bf16 v40, v107, v19
    s_waitcnt vmcnt(12)
    v_dot2c_f32_bf16 v41, v108, v8
    v_dot2c_f32_bf16 v41, v109, v9
    v_dot2c_f32_bf16 v41, v110, v10
    v_dot2c_f32_bf16 v41, v111, v11
    v_dot2c_f32_bf16 v41, v112, v12
    v_dot2c_f32_bf16 v41, v113, v13
    v_dot2c_f32_bf16 v41, v114, v14
    v_dot2c_f32_bf16 v41, v115, v15
    v_dot2c_f32_bf16 v41, v116, v16
    v_dot2c_f32_bf16 v41, v117, v17
    v_dot2c_f32_bf16 v41, v118, v18
    v_dot2c_f32_bf16 v41, v119, v19
    s_nop 2
    v_add_f32_dpp v40, v40, v40 quad_perm:[1,0,3,2] row_mask:0xf bank_mask:0xf
    v_add_f32_dpp v41, v41, v41 quad_perm:[1,0,3,2] row_mask:0xf bank_mask:0xf
    s_nop 0
    v_add_f32_dpp v40, v40, v40 quad_perm:[2,3,0,1] row_mask:0xf bank_mask:0xf
    v_add_f32_dpp v41, v41, v41 quad_perm:[2,3,0,1] row_mask:0xf bank_mask:0xf
    s_nop 0
    v_add_f32_dpp v40, v40, v40 row_half_mirror row_mask:0xf bank_mask:0xf
    v_add_f32_dpp v41, v41, v41 row_half_mirror row_mask:0xf bank_mask:0xf
    s_nop 0
    v_cvt_pk_bf16_f32 v42, v40, v41
    v_lshlrev_b32 v40, 16, v42
    v_and_b32 v41, 0xffff0000, v42
WS_1:
    s_cbranch_execz WS_p5
    v_mul_f32 v40, 1033096506, v40
    v_mul_f32 v41, 1033096506, v41
    v_cvt_pk_bf16_f32 v42, v40, v41
    v_lshlrev_b32 v40, 16, v42
    v_and_b32 v41, 0xffff0000, v42
    v_max_f32 v42, v40, v41
    v_cmp_gt_f32 vcc, v42, v43
    s_cbranch_vccz L_skip_7
    v_max_f32_dpp v42, v42, v42 row_ror:8 row_mask:0xf bank_mask:0xf
    v_mov_b32 v46, v42
    s_nop 1
    v_permlane16_swap_b32 v42, v46
    s_nop 0
    v_max_f32 v42, v42, v46
    v_mov_b32 v46, v42
    s_nop 1
    v_permlane32_swap_b32 v42, v46
    s_nop 0
    v_max_f32 v42, v42, v46
    v_max_f32 v43, v43, v42
    v_mul_f32 v46, s46, v43
    v_sub_f32 v47, v44, v46
    v_exp_f32 v47, v47
    v_mov_b32 v44, v46
    v_mul_f32 v45, v45, v47
    v_mul_f32 v20, v20, v47
    v_mul_f32 v21, v21, v47
    v_mul_f32 v22, v22, v47
    v_mul_f32 v23, v23, v47
    v_mul_f32 v24, v24, v47
    v_mul_f32 v25, v25, v47
    v_mul_f32 v26, v26, v47
    v_mul_f32 v27, v27, v47
    v_mul_f32 v28, v28, v47
    v_mul_f32 v29, v29, v47
    v_mul_f32 v30, v30, v47
    v_mul_f32 v31, v31, v47
L_skip_7:
    v_fma_f32 v46, v40, s46, -v44
    v_fma_f32 v47, v41, s46, -v44
    v_exp_f32 v46, v46
    v_exp_f32 v47, v47
WS_p5:
    s_cbranch_execz WS_p6
    s_nop 0
    v_add_f32 v45, v45, v46
    v_cvt_pk_bf16_f32 v46, v46, v46
    v_add_f32 v45, v45, v47
    v_cvt_pk_bf16_f32 v47, v47, v47
    v_and_b32 v32, v46, v4
    v_and_b32 v33, v46, v5
    v_and_b32 v34, v46, v6
    v_and_b32 v35, v46, v7
    v_and_b32 v36, v47, v4
    v_and_b32 v37, v47, v5
    v_and_b32 v38, v47, v6
    v_and_b32 v39, v47, v7
    s_cmp_lg_u32 s45, 0
    s_cbranch_scc1 L_Fl
    s_waitcnt vmcnt(9)
    v_mfma_f32_16x16x32_bf16 v[20:23], v[32:35], v[120:123], v[20:23]
    v_mfma_f32_16x16x32_bf16 v[24:27], v[32:35], v[124:127], v[24:27]
    v_mfma_f32_16x16x32_bf16 v[28:31], v[32:35], v[128:131], v[28:31]
    s_waitcnt vmcnt(6)
    v_mfma_f32_16x16x32_bf16 v[20:23], v[36:39], v[132:135], v[20:23]
    v_mfma_f32_16x16x32_bf16 v[24:27], v[36:39], v[136:139], v[24:27]
    v_mfma_f32_16x16x32_bf16 v[28:31], v[36:39], v[140:143], v[28:31]
L_loop:
    v_mov_b32 v40, 0
    v_mov_b32 v41, 0
    s_waitcnt vmcnt(3)
    s_cmp_eq_u32 s41, 2
    s_cbranch_scc1 L_xg
    v_dot2c_f32_bf16 v40, v48, v8
    v_dot2c_f32_bf16 v40, v49, v9
    v_dot2c_f32_bf16 v40, v50, v10
    v_dot2c_f32_bf16 v40, v51, v11
    v_dot2c_f32_bf16 v40, v52, v12
    v_dot2c_f32_bf16 v40, v53, v13
    v_dot2c_f32_bf16 v40, v54, v14
    v_dot2c_f32_bf16 v40, v55, v15
    v_dot2c_f32_bf16 v40, v56, v16
    v_dot2c_f32_bf16 v40, v57, v17
    v_dot2c_f32_bf16 v40, v58, v18
    v_dot2c_f32_bf16 v40, v59, v19
L_xg_ret:
WS_p6:
    s_cbranch_execz WS_p7
    buffer_load_dwordx4 v[72:75], v2, s[32:35], s43 offen offset:0 nt
    buffer_load_dwordx4 v[76:79], v2, s[32:35], s43 offen offset:128 nt
    buffer_load_dwordx4 v[80:83], v2, s[32:35], s43 offen offset:256 nt
L_sk0:
    s_waitcnt vmcnt(3)
    v_dot2c_f32_bf16 v41, v60, v8
    v_dot2c_f32_bf16 v41, v61, v9
    v_dot2c_f32_bf16 v41, v62, v10
    v_dot2c_f32_bf16 v41, v63, v11
    v_dot2c_f32_bf16 v41, v64, v12
    v_dot2c_f32_bf16 v41, v65, v13
    v_dot2c_f32_bf16 v41, v66, v14
    v_dot2c_f32_bf16 v41, v67, v15
    v_dot2c_f32_bf16 v41, v68, v16
    v_dot2c_f32_bf16 v41, v69, v17
    v_dot2c_f32_bf16 v41, v70, v18
    v_dot2c_f32_bf16 v41, v71, v19
    buffer_load_dwordx4 v[84:87], v2, s[32:35], s43 offen offset:3072 nt
    buffer_load_dwordx4 v[88:91], v2, s[32:35], s43 offen offset:3200 nt
    buffer_load_dwordx4 v[92:95], v2, s[32:35], s43 offen offset:3328 nt
L_sk1:
    s_nop 0
    v_add_f32_dpp v40, v40, v40 quad_perm:[1,0,3,2] row_mask:0xf bank_mask:0xf
    v_add_f32_dpp v41, v41, v41 quad_perm:[1,0,3,2] row_mask:0xf bank_mask:0xf
    s_nop 0
    v_add_f32_dpp v40, v40, v40 quad_perm:[2,3,0,1] row_mask:0xf bank_mask:0xf
    v_add_f32_dpp v41, v41, v41 quad_perm:[2,3,0,1] row_mask:0xf bank_mask:0xf
    s_nop 0
    v_add_f32_dpp v40, v40, v40 row_half_mirror row_mask:0xf bank_mask:0xf
    v_add_f32_dpp v41, v41, v41 row_half_mirror row_mask:0xf bank_mask:0xf
    s_nop 0
    v_cvt_pk_bf16_f32 v42, v40, v41
    v_lshlrev_b32 v40, 16, v42
    v_and_b32 v41, 0xffff0000, v42
    v_mul_f32 v40, 1033096506, v40
WS_p7:
    s_cbranch_execz L_ws_ret
    v_mul_f32 v41, 1033096506, v41
    v_cvt_pk_bf16_f32 v42, v40, v41
    v_lshlrev_b32 v40, 16, v42
    v_and_b32 v41, 0xffff0000, v42
    v_max_f32 v42, v40, v41
    v_cmp_gt_f32 vcc, v42, v43
    s_cbranch_vccz L_skip_8
    v_max_f32_dpp v42, v42, v42 row_ror:8 row_mask:0xf bank_mask:0xf
    v_mov_b32 v46, v42
    s_nop 1
    v_permlane16_swap_b32 v42, v46
    s_nop 0
    v_max_f32 v42, v42, v46
    v_mov_b32 v46, v42
    s_nop 1
    v_permlane32_swap_b32 v42, v46
    s_nop 0
    v_max_f32 v42, v42, v46
    v_max_f32 v43, v43, v42
    v_mul_f32 v46, s46, v43
    v_sub_f32 v47, v44, v46
    v_exp_f32 v47, v47
    v_mov_b32 v44, v46
    v_mul_f32 v45, v45, v47
    v_mul_f32 v20, v20, v47
    v_mul_f32 v21, v21, v47
    v_mul_f32 v22, v22, v47
    v_mul_f32 v23, v23, v47
    v_mul_f32 v24, v24, v47
    v_mul_f32 v25, v25, v47
    v_mul_f32 v26, v26, v47
    v_mul_f32 v27, v27, v47
    v_mul_f32 v28, v28, v47
    v_mul_f32 v29, v29, v47
    v_mul_f32 v30, v30, v47
    v_mul_f32 v31, v31, v47
L_skip_8:
    v_fma_f32 v46, v40, s46, -v44
    v_fma_f32 v47, v41, s46, -v44
    v_exp_f32 v46, v46
    v_exp_f32 v47, v47
    s_nop 0
    v_add_f32 v45, v45, v46
WS_2:
    s_cbranch_execz WS_p9
    v_cvt_pk_bf16_f32 v46, v46, v46
    v_add_f32 v45, v45, v47
    v_cvt_pk_bf16_f32 v47, v47, v47
    v_and_b32 v32, v46, v4
    v_and_b32 v33, v46, v5
    v_and_b32 v34, v46, v6
    v_and_b32 v35, v46, v7
    v_and_b32 v36, v47, v4
    v_and_b32 v37, v47, v5
    v_and_b32 v38, v47, v6
    v_and_b32 v39, v47, v7
    s_waitcnt vmcnt(3)
    v_mfma_f32_16x16x32_bf16 v[20:23], v[32:35], v[72:75], v[20:23]
    v_mfma_f32_16x16x32_bf16 v[24:27], v[32:35], v[76:79], v[24:27]
    v_mfma_f32_16x16x32_bf16 v[28:31], v[32:35], v[80:83], v[28:31]
    s_cmp_ge_u32 s85, 240
    s_cbranch_scc1 L_last
    s_add_u32 s48, s85, s94
    s_and_b32 s48, s48, 255
    s_mul_i32 s48, s48, 6144
    s_add_u32 s99, s40, s48
    buffer_load_dwordx4 v[48:51], v2, s[28:31], s99 offen offset:0 nt
    buffer_load_dwordx4 v[52:55], v2, s[28:31], s99 offen offset:128 nt
    buffer_load_dwordx4 v[56:59], v2, s[28:31], s99 offen offset:256 nt
L_skx:
    s_add_u32 s48, s85, 4
    s_and_b32 s48, s48, 15
    s_andn2_b32 s85, s85, 15
    s_add_u32 s85, s85, s48
    s_add_u32 s85, s85, 16
    s_waitcnt vmcnt(3)
    v_mfma_f32_16x16x32_bf16 v[20:23], v[36:39], v[84:87], v[20:23]
    v_mfma_f32_16x16x32_bf16 v[24:27], v[36:39], v[88:91], v[24:27]
    v_mfma_f32_16x16x32_bf16 v[28:31], v[36:39], v[92:95], v[28:31]
WS_p9:
    s_cbranch_execz WS_p10
    buffer_load_dwordx4 v[60:63], v2, s[28:31], s99 offen offset:3072 nt
    buffer_load_dwordx4 v[64:67], v2, s[28:31], s99 offen offset:3200 nt
    buffer_load_dwordx4 v[68:71], v2, s[28:31], s99 offen offset:3328 nt
    s_mov_b32 s43, s99
    s_branch L_loop
L_xg:
    s_mov_b32 s41, 0
    v_dot2c_f32_bf16 v40, v156, v8
    v_dot2c_f32_bf16 v40, v157, v9
    v_dot2c_f32_bf16 v40, v158, v10
    v_dot2c_f32_bf16 v40, v159, v11
    v_dot2c_f32_bf16 v40, v160, v12
    v_dot2c_f32_bf16 v40, v161, v13
    v_dot2c_f32_bf16 v40, v162, v14
    v_dot2c_f32_bf16 v40, v163, v15
    v_dot2c_f32_bf16 v40, v164, v16
    v_dot2c_f32_bf16 v40, v165, v17
    v_dot2c_f32_bf16 v40, v166, v18
    v_dot2c_f32_bf16 v40, v167, v19
    s_branch L_xg_ret
L_last:
    s_mov_b32 s45, 1
    buffer_load_dwordx4 v[96:99], v2, s[28:31], s44 offen offset:0 nt
    buffer_load_dwordx4 v[100:103], v2, s[28:31], s44 offen offset:128 nt
    buffer_load_dwordx4 v[104:107], v2, s[28:31], s44 offen offset:256 nt
    buffer_load_dwordx4 v[108:111], v2, s[28:31], s44 offen offset:3072 nt
    buffer_load_dwordx4 v[112:115], v2, s[28:31], s44 offen offset:3200 nt
    buffer_load_dwordx4 v[116:119], v2, s[28:31], s44 offen offset:3328 nt
    buffer_load_dwordx4 v[120:123], v2, s[32:35], s44 offen offset:0 nt
    buffer_load_dwordx4 v[124:127], v2, s[32:35], s44 offen offset:128 nt
    buffer_load_dwordx4 v[128:131], v2, s[32:35], s44 offen offset:256 nt
    buffer_load_dwordx4 v[132:135], v2, s[32:35], s44 offen offset:3072 nt
    buffer_load_dwordx4 v[136:139], v2, s[32:35], s44 offen offset:3200 nt
    buffer_load_dwordx4 v[140:143], v2, s[32:35], s44 offen offset:3328 nt
WS_p10:
    s_cbranch_execz WS_p11
    buffer_load_dword v144, v145, s[36:39], 0 offen
    buffer_load_dword v144, v145, s[36:39], 0 offen
    buffer_load_dword v144, v145, s[36:39], 0 offen
    buffer_load_dword v144, v145, s[36:39], 0 offen
    buffer_load_dword v144, v145, s[36:39], 0 offen
    buffer_load_dword v144, v145, s[36:39], 0 offen
    s_waitcnt vmcnt(18)
    v_mfma_f32_16x16x32_bf16 v[20:23], v[36:39], v[84:87], v[20:23]
    v_mfma_f32_16x16x32_bf16 v[24:27], v[36:39], v[88:91], v[24:27]
    v_mfma_f32_16x16x32_bf16 v[28:31], v[36:39], v[92:95], v[28:31]
    s_branch L_F
L_Fl:
    buffer_load_dwordx4 v[48:51], v3, s[36:39], s72 offen offset:0 nt
    buffer_load_dwordx4 v[52:55], v3, s[36:39], s72 offen offset:1280 nt
    buffer_load_dwordx4 v[56:59], v3, s[36:39], s72 offen offset:2560 nt
    buffer_load_dwordx4 v[60:63], v3, s[36:39], s72 offen offset:3840 nt
    buffer_load_dwordx4 v[64:67], v3, s[36:39], s73 offen offset:0 nt
    buffer_load_dwordx4 v[68:71], v3, s[36:39], s73 offen offset:1280 nt
    buffer_load_dwordx4 v[72:75], v3, s[36:39], s73 offen offset:2560 nt
    buffer_load_dwordx4 v[76:79], v3, s[36:39], s73 offen offset:3840 nt
    v_add_f32_dpp v45, v45, v45 row_ror:8 row_mask:0xf bank_mask:0xf
    v_mov_b32 v42, v45
    s_nop 1
    v_permlane16_swap_b32 v45, v42
    s_nop 0
    v_add_f32 v45, v45, v42
    v_mov_b32 v42, v45
    s_nop 1
    v_permlane32_swap_b32 v45, v42
    s_nop 0
    v_add_f32 v45, v45, v42
WS_p11:
    s_cbranch_execz L_ws_ret
    ds_write_b64 v153, v[44:45] offset:960
    s_waitcnt vmcnt(17)
    v_mfma_f32_16x16x32_bf16 v[20:23], v[32:35], v[120:123], v[20:23]
    v_mfma_f32_16x16x32_bf16 v[24:27], v[32:35], v[124:127], v[24:27]
    v_mfma_f32_16x16x32_bf16 v[28:31], v[32:35], v[128:131], v[28:31]
    s_waitcnt vmcnt(14)
    v_mfma_f32_16x16x32_bf16 v[20:23], v[36:39], v[132:135], v[20:23]
    v_mfma_f32_16x16x32_bf16 v[24:27], v[36:39], v[136:139], v[24:27]
    v_mfma_f32_16x16x32_bf16 v[28:31], v[36:39], v[140:143], v[28:31]
L_exit:
    s_nop 6
    ds_write_b128 v152, v[20:23] offset:5120
    ds_write_b128 v152, v[24:27] offset:6144
    ds_write_b128 v152, v[28:31] offset:7168
    s_waitcnt lgkmcnt(0)
    s_barrier
    s_cmp_lg_u32 s83, 0
    s_cbranch_scc1 L_sdone
L_pollO:
    global_load_dwordx4 v[108:111], v148, s[92:93] sc1
    global_load_dwordx4 v[112:115], v149, s[92:93] offset:768 sc1
    s_waitcnt vmcnt(0)
    v_xor_b32 v108, s80, v108
    v_xor_b32 v109, s0, v109
    v_xor_b32 v110, s1, v110
    v_xor_b32 v111, s14, v111
    v_xor_b32 v112, s80, v112
    v_xor_b32 v113, s0, v113
    v_xor_b32 v114, s1, v114
    v_xor_b32 v115, s14, v115
    v_or_b32 v42, v108, v109
    v_or3_b32 v42, v42, v110, v111
    v_or3_b32 v42, v42, v112, v113
    v_or3_b32 v42, v42, v114, v115
WS_3:
    s_cbranch_execz WS_p13
    v_and_b32 v42, 511, v42
    v_cmp_ne_u32 vcc, 0, v42
    s_cbranch_vccz L_gotO
    s_and_b32 s47, s58, s89
    s_cmp_eq_u32 s47, 0
    s_cselect_b64 s[92:93], s[90:91], s[26:27]
    s_sleep 1
    s_sub_u32 s58, s58, 1
    s_cmp_gt_i32 s58, 0
    s_cbranch_scc1 L_pollO
L_gotO:
    v_max_f32_dpp v42, v112, v112 quad_perm:[1,0,3,2] row_mask:0xf bank_mask:0xf
    s_nop 1
    v_max_f32_dpp v42, v42, v42 quad_perm:[2,3,0,1] row_mask:0xf bank_mask:0xf
    v_sub_f32 v42, v112, v42
    v_exp_f32 v42, v42
    s_nop 0
    v_mul_f32 v136, v113, v42
    v_mul_f32 v132, v108, v42
    v_mul_f32 v133, v109, v42
    v_mul_f32 v134, v110, v42
    v_mul_f32 v135, v111, v42
L_ocommon:
    v_add_f32_dpp v136, v136, v136 quad_perm:[1,0,3,2] row_mask:0xf bank_mask:0xf
    v_add_f32_dpp v132, v132, v132 quad_perm:[1,0,3,2] row_mask:0xf bank_mask:0xf
    v_add_f32_dpp v133, v133, v133 quad_perm:[1,0,3,2] row_mask:0xf bank_mask:0xf
    v_add_f32_dpp v134, v134, v134 quad_perm:[1,0,3,2] row_mask:0xf bank_mask:0xf
    v_add_f32_dpp v135, v135, v135 quad_perm:[1,0,3,2] row_mask:0xf bank_mask:0xf
    v_add_f32_dpp v136, v136, v136 quad_perm:[2,3,0,1] row_mask:0xf bank_mask:0xf
    v_add_f32_dpp v132, v132, v132 quad_perm:[2,3,0,1] row_mask:0xf bank_mask:0xf
    v_add_f32_dpp v133, v133, v133 quad_perm:[2,3,0,1] row_mask:0xf bank_mask:0xf
    v_add_f32_dpp v134, v134, v134 quad_perm:[2,3,0,1] row_mask:0xf bank_mask:0xf
    v_add_f32_dpp v135, v135, v135 quad_perm:[2,3,0,1] row_mask:0xf bank_mask:0xf
    v_rcp_f32 v42, v136
    s_nop 0
    v_mul_f32 v132, v132, v42
    v_mul_f32 v133, v133, v42
WS_p13:
    s_cbranch_execz WS_p14
    v_mul_f32 v134, v134, v42
    v_mul_f32 v135, v135, v42
    v_cvt_pk_bf16_f32 v132, v132, v132
    v_cvt_pk_bf16_f32 v133, v133, v133
    v_cvt_pk_bf16_f32 v134, v134, v134
    v_cvt_pk_bf16_f32 v135, v135, v135
    ds_bpermute_b32 v96, v150, v132
    ds_bpermute_b32 v97, v150, v133
    ds_bpermute_b32 v98, v150, v134
    ds_bpermute_b32 v99, v150, v135
    ds_bpermute_b32 v100, v151, v132
    ds_bpermute_b32 v101, v151, v133
    ds_bpermute_b32 v102, v151, v134
    ds_bpermute_b32 v103, v151, v135
    s_waitcnt lgkmcnt(7)
    v_and_b32 v32, v96, v4
    v_and_b32 v33, v96, v5
    v_and_b32 v34, v96, v6
    v_and_b32 v35, v96, v7
    s_waitcnt lgkmcnt(6)
    v_and_b32 v36, v97, v4
    v_and_b32 v37, v97, v5
    v_and_b32 v38, v97, v6
    v_and_b32 v39, v97, v7
    v_mfma_f32_16x16x32_bf16 v[20:23], v[32:35], v[48:51], 0
    s_waitcnt lgkmcnt(5)
    v_and_b32 v116, v98, v4
    v_and_b32 v117, v98, v5
    v_and_b32 v118, v98, v6
    v_and_b32 v119, v98, v7
    v_mfma_f32_16x16x32_bf16 v[20:23], v[36:39], v[52:55], v[20:23]
    s_waitcnt lgkmcnt(4)
    v_and_b32 v120, v99, v4
    v_and_b32 v121, v99, v5
WS_p14:
    s_cbranch_execz L_ws_ret
    v_and_b32 v122, v99, v6
    v_and_b32 v123, v99, v7
    v_mfma_f32_16x16x32_bf16 v[20:23], v[116:119], v[56:59], v[20:23]
    s_waitcnt lgkmcnt(3)
    v_and_b32 v32, v100, v4
    v_and_b32 v33, v100, v5
    v_and_b32 v34, v100, v6
    v_and_b32 v35, v100, v7
    v_mfma_f32_16x16x32_bf16 v[20:23], v[120:123], v[60:63], v[20:23]
    s_waitcnt lgkmcnt(2)
    v_and_b32 v36, v101, v4
    v_and_b32 v37, v101, v5
    v_and_b32 v38, v101, v6
    v_and_b32 v39, v101, v7
    v_mfma_f32_16x16x32_bf16 v[20:23], v[32:35], v[64:67], v[20:23]
    s_waitcnt lgkmcnt(1)
    v_and_b32 v116, v102, v4
    v_and_b32 v117, v102, v5
    v_and_b32 v118, v102, v6
    v_and_b32 v119, v102, v7
    v_mfma_f32_16x16x32_bf16 v[20:23], v[36:39], v[68:71], v[20:23]
    s_waitcnt lgkmcnt(0)
    v_and_b32 v120, v103, v4
    v_and_b32 v121, v103, v5
    v_and_b32 v122, v103, v6
    v_and_b32 v123, v103, v7
    v_mfma_f32_16x16x32_bf16 v[20:23], v[116:119], v[72:75], v[20:23]
    s_nop 0
    v_mfma_f32_16x16x32_bf16 v[20:23], v[120:123], v[76:79], v[20:23]
    s_nop 7
    ds_write_b128 v154, v[20:23] offset:1024
    s_waitcnt lgkmcnt(0)
    s_barrier
L_sdone:
    s_endpgm
L_aux2:
    s_setprio 0
    s_mul_i32 s96, s95, 15
    s_add_u32 s96, s96, s101
    s_sub_u32 s69, s101, 15
    s_sub_u32 s70, s101, 24
    s_cmp_ge_u32 s101, 30
    s_cselect_b32 s69, s70, s69
    s_cselect_b32 s48, 0, s69
    s_lshl_b32 s70, s95, 3
    s_add_u32 s70, s70, s69
    s_add_u32 s70, s70, 120
    s_cmp_lt_u32 s48, 6
    s_cselect_b32 s70, s70, 255
    s_cmp_lt_u32 s101, 15
    s_cselect_b32 s96, s96, s70
    s_mul_i32 s59, s95, 10
    s_sub_u32 s69, s101, 21
    s_add_u32 s59, s59, s69
    s_cmp_lt_u32 s69, 10
    s_cselect_b32 s59, s59, 255
    s_lshl_b32 s68, s66, 3
    s_lshl_b32 s47, s67, 2
    s_add_u32 s68, s68, s47
    s_add_u32 s68, s68, s49
    s_lshl_b32 s68, s68, 10
    s_add_u32 s68, s68, 327680
    s_add_u32 s98, s101, 17
    s_and_b32 s98, s98, 31
    s_cmp_ge_u32 s98, 30
    s_cselect_b32 s83, 1, 0
    s_mul_i32 s74, s95, 30
    s_add_u32 s74, s74, s98
    s_lshl_b32 s74, s74, 10
    s_add_u32 s74, s74, 589824
    s_lshl_b32 s47, s96, 10
    s_add_u32 s75, s47, 1048576
    s_add_u32 s48, s47, 712704
    s_cmp_lt_u32 s96, 120
    s_cselect_b32 s75, s75, s48
    s_mul_i32 s69, s96, 205
    s_lshr_b32 s69, s69, 10
    s_mul_i32 s70, s69, 5
    s_sub_u32 s70, s96, s70
    s_mov_b32 s63, 0
    s_cmp_lt_u32 s96, 120
    s_cbranch_scc1 L_gtask
L_wo:
    s_sub_u32 s47, s96, 120
    s_cmp_lt_u32 s47, 60
    s_cbranch_scc0 L_ffn_done
    s_sub_u32 s76, s69, 24
    s_mul_i32 s47, s76, 10240
    s_add_u32 s47, s47, 1052672
    v_lshl_add_u32 v164, v1, 4, s47
    v_add_u32 v165, 5120, v164
    s_sub_u32 s47, s47, 4096
    v_lshl_add_u32 v167, v1, 10, s47
    s_mov_b64 exec, 0x3ff
L_probeG:
    s_sleep 16
    global_load_dwordx4 v[32:35], v167, s[26:27] offset:1008 sc1
    s_waitcnt vmcnt(0)
    v_xor_b32 v32, s80, v32
    v_xor_b32 v33, s0, v33
    v_xor_b32 v34, s1, v34
    v_xor_b32 v35, s14, v35
    v_or_b32 v166, v32, v33
    v_or3_b32 v166, v166, v34, v35
    v_and_b32 v166, 511, v166
    v_cmp_ne_u32 vcc, 0, v166
    s_cbranch_vccz L_probedG
    s_sub_u32 s58, s58, 1
    s_cmp_gt_i32 s58, 0
    s_cbranch_scc1 L_probeG
L_probedG:
    s_mov_b64 exec, -1
L_pollG:
    global_load_dwordx4 v[32:35], v164, s[26:27] offset:-4096 sc1
    global_load_dwordx4 v[36:39], v164, s[26:27] offset:-3072 sc1
    global_load_dwordx4 v[40:43], v164, s[26:27] offset:-2048 sc1
    global_load_dwordx4 v[44:47], v164, s[26:27] offset:-1024 sc1
    global_load_dwordx4 v[48:51], v164, s[26:27] offset:0 sc1
    global_load_dwordx4 v[52:55], v165, s[26:27] offset:-4096 sc1
    global_load_dwordx4 v[56:59], v165, s[26:27] offset:-3072 sc1
    global_load_dwordx4 v[60:63], v165, s[26:27] offset:-2048 sc1
    global_load_dwordx4 v[64:67], v165, s[26:27] offset:-1024 sc1
    global_load_dwordx4 v[68:71], v165, s[26:27] offset:0 sc1
    s_waitcnt vmcnt(0)
    v_xor_b32 v32, s80, v32
    v_xor_b32 v33, s0, v33
    v_xor_b32 v34, s1, v34
    v_xor_b32 v35, s14, v35
    v_xor_b32 v36, s80, v36
    v_xor_b32 v37, s0, v37
    v_xor_b32 v38, s1, v38
    v_xor_b32 v39, s14, v39
    v_xor_b32 v40, s80, v40
    v_xor_b32 v41, s0, v41
    v_xor_b32 v42, s1, v42
    v_xor_b32 v43, s14, v43
    v_xor_b32 v44, s80, v44
    v_xor_b32 v45, s0, v45
    v_xor_b32 v46, s1, v46
    v_xor_b32 v47, s14, v47
    v_xor_b32 v48, s80, v48
    v_xor_b32 v49, s0, v49
    v_xor_b32 v50, s1, v50
    v_xor_b32 v51, s14, v51
    v_xor_b32 v52, s80, v52
    v_xor_b32 v53, s0, v53
    v_xor_b32 v54, s1, v54
    v_xor_b32 v55, s14, v55
    v_xor_b32 v56, s80, v56
    v_xor_b32 v57, s0, v57
    v_xor_b32 v58, s1, v58
    v_xor_b32 v59, s14, v59
    v_xor_b32 v60, s80, v60
    v_xor_b32 v61, s0, v61
    v_xor_b32 v62, s1, v62
    v_xor_b32 v63, s14, v63
    v_xor_b32 v64, s80, v64
    v_xor_b32 v65, s0, v65
    v_xor_b32 v66, s1, v66
    v_xor_b32 v67, s14, v67
    v_xor_b32 v68, s80, v68
    v_xor_b32 v69, s0, v69
    v_xor_b32 v70, s1, v70
    v_xor_b32 v71, s14, v71
    v_or_b32 v166, v32, v33
    v_or3_b32 v166, v166, v34, v35
    v_or3_b32 v166, v166, v36, v37
    v_or3_b32 v166, v166, v38, v39
    v_or3_b32 v166, v166, v40, v41
    v_or3_b32 v166, v166, v42, v43
    v_or3_b32 v166, v166, v44, v45
    v_or3_b32 v166, v166, v46, v47
    v_or3_b32 v166, v166, v48, v49
    v_or3_b32 v166, v166, v50, v51
    v_or3_b32 v166, v166, v52, v53
    v_or3_b32 v166, v166, v54, v55
    v_or3_b32 v166, v166, v56, v57
    v_or3_b32 v166, v166, v58, v59
    v_or3_b32 v166, v166, v60, v61
    v_or3_b32 v166, v166, v62, v63
    v_or3_b32 v166, v166, v64, v65
    v_or3_b32 v166, v166, v66, v67
    v_or3_b32 v166, v166, v68, v69
    v_or3_b32 v166, v166, v70, v71
    v_and_b32 v166, 511, v166
    v_cmp_ne_u32 vcc, 0, v166
    s_cbranch_vccz L_gotG
    s_sleep 16
    s_sub_u32 s58, s58, 1
    s_cmp_gt_i32 s58, 0
    s_cbranch_scc1 L_pollG
L_gotG:
    v_add_f32 v32, v32, v36
    v_add_f32 v33, v33, v37
    v_add_f32 v34, v34, v38
    v_add_f32 v35, v35, v39
    v_add_f32 v32, v32, v40
    v_add_f32 v33, v33, v41
    v_add_f32 v34, v34, v42
    v_add_f32 v35, v35, v43
    v_add_f32 v32, v32, v44
    v_add_f32 v33, v33, v45
    v_add_f32 v34, v34, v46
    v_add_f32 v35, v35, v47
    v_add_f32 v32, v32, v48
    v_add_f32 v33, v33, v49
    v_add_f32 v34, v34, v50
    v_add_f32 v35, v35, v51
    v_add_f32 v52, v52, v56
    v_add_f32 v53, v53, v57
    v_add_f32 v54, v54, v58
    v_add_f32 v55, v55, v59
    v_add_f32 v52, v52, v60
    v_add_f32 v53, v53, v61
    v_add_f32 v54, v54, v62
    v_add_f32 v55, v55, v63
    v_add_f32 v52, v52, v64
    v_add_f32 v53, v53, v65
    v_add_f32 v54, v54, v66
    v_add_f32 v55, v55, v67
    v_add_f32 v52, v52, v68
    v_add_f32 v53, v53, v69
    v_add_f32 v54, v54, v70
    v_add_f32 v55, v55, v71
    v_cvt_pk_bf16_f32 v32, v32, v32
    v_and_b32 v32, 0xffff0000, v32
    v_cvt_pk_bf16_f32 v52, v52, v52
    v_and_b32 v52, 0xffff0000, v52
    v_mul_f32 v166, v32, v32
    v_mul_f32 v166, v166, v32
    v_mov_b32 v167, v32
    v_fmac_f32 v167, 0x3d372713, v166
    v_mul_f32 v167, 0xc0135761, v167
    v_exp_f32 v167, v167
    s_nop 0
    v_add_f32 v167, 1.0, v167
    v_rcp_f32 v167, v167
    s_nop 0
    v_mul_f32 v32, v32, v167
    v_cvt_pk_bf16_f32 v32, v32, v32
    v_and_b32 v32, 0xffff0000, v32
    v_mul_f32 v32, v32, v52
    v_cvt_pk_bf16_f32 v33, v33, v33
    v_and_b32 v33, 0xffff0000, v33
    v_cvt_pk_bf16_f32 v53, v53, v53
    v_and_b32 v53, 0xffff0000, v53
    v_mul_f32 v166, v33, v33
    v_mul_f32 v166, v166, v33
    v_mov_b32 v167, v33
    v_fmac_f32 v167, 0x3d372713, v166
    v_mul_f32 v167, 0xc0135761, v167
    v_exp_f32 v167, v167
    s_nop 0
    v_add_f32 v167, 1.0, v167
    v_rcp_f32 v167, v167
    s_nop 0
    v_mul_f32 v33, v33, v167
    v_cvt_pk_bf16_f32 v33, v33, v33
    v_and_b32 v33, 0xffff0000, v33
    v_mul_f32 v33, v33, v53
    v_cvt_pk_bf16_f32 v34, v34, v34
    v_and_b32 v34, 0xffff0000, v34
    v_cvt_pk_bf16_f32 v54, v54, v54
    v_and_b32 v54, 0xffff0000, v54
    v_mul_f32 v166, v34, v34
    v_mul_f32 v166, v166, v34
    v_mov_b32 v167, v34
    v_fmac_f32 v167, 0x3d372713, v166
    v_mul_f32 v167, 0xc0135761, v167
    v_exp_f32 v167, v167
    s_nop 0
    v_add_f32 v167, 1.0, v167
    v_rcp_f32 v167, v167
    s_nop 0
    v_mul_f32 v34, v34, v167
    v_cvt_pk_bf16_f32 v34, v34, v34
    v_and_b32 v34, 0xffff0000, v34
    v_mul_f32 v34, v34, v54
    v_cvt_pk_bf16_f32 v35, v35, v35
    v_and_b32 v35, 0xffff0000, v35
    v_cvt_pk_bf16_f32 v55, v55, v55
    v_and_b32 v55, 0xffff0000, v55
    v_mul_f32 v166, v35, v35
    v_mul_f32 v166, v166, v35
    v_mov_b32 v167, v35
    v_fmac_f32 v167, 0x3d372713, v166
    v_mul_f32 v167, 0xc0135761, v167
    v_exp_f32 v167, v167
    s_nop 0
    v_add_f32 v167, 1.0, v167
    v_rcp_f32 v167, v167
    s_nop 0
    v_mul_f32 v35, v35, v167
    v_cvt_pk_bf16_f32 v35, v35, v35
    v_and_b32 v35, 0xffff0000, v35
    v_mul_f32 v35, v35, v55
    v_cvt_pk_bf16_f32 v32, v32, v33
    v_cvt_pk_bf16_f32 v33, v34, v35
    v_lshrrev_b32 v164, 4, v1
    v_lshlrev_b32 v164, 6, v164
    v_and_b32 v165, 8, v1
    v_lshl_add_u32 v164, v165, 5, v164
    v_and_b32 v165, 15, v1
    v_lshlrev_b32 v165, 4, v165
    v_and_b32 v166, 32, v1
    v_lshl_add_u32 v165, v166, 3, v165
    v_bfe_u32 v166, v1, 4, 1
    v_lshl_add_u32 v165, v166, 3, v165
    ds_write_b64 v165, v[32:33] offset:0
    s_waitcnt lgkmcnt(0)
    ds_read_b128 v[8:11], v164 offset:0
    ds_read_b128 v[12:15], v164 offset:16
    ds_read_b128 v[16:19], v164 offset:32
    ds_read_b128 v[20:23], v164 offset:48
    v_lshrrev_b32 v164, 4, v1
    v_mul_u32_u24 v2, 40960, v164
    v_and_b32 v165, 15, v1
    v_lshl_add_u32 v2, v165, 4, v2
    s_mul_i32 s47, s76, 163840
    s_lshl_b32 s48, s70, 8
    s_add_u32 s47, s47, s48
    v_add_u32 v2, s47, v2
    v_mov_b32 v3, 0
    s_mov_b32 s62, 1280
    v_lshl_add_u64 v[2:3], v[2:3], 0, s[20:21]
    v_and_b32 v166, 15, v1
    v_lshlrev_b32 v166, 5, v166
    v_and_b32 v165, 16, v1
    v_add_u32 v166, v166, v165
    v_and_b32 v165, 32, v1
    v_lshl_add_u32 v166, v165, 4, v166
    v_add_u32 v166, s75, v166
    s_waitcnt lgkmcnt(0)
    s_branch L_tile2
L_gtask:
    v_lshrrev_b32 v164, 4, v1
    v_mul_u32_u24 v2, 98304, v164
    v_and_b32 v165, 15, v1
    v_lshl_add_u32 v2, v165, 4, v2
    s_mul_i32 s47, s70, 393216
    s_lshr_b32 s48, s69, 1
    s_lshl_b32 s48, s48, 8
    s_add_u32 s47, s47, s48
    v_add_u32 v2, s47, v2
    v_mov_b32 v3, 0
    s_mov_b32 s62, 3072
    s_bitcmp1_b32 s69, 0
    s_cselect_b64 s[50:51], s[18:19], s[16:17]
    v_lshl_add_u64 v[2:3], v[2:3], 0, s[50:51]
    v_lshl_add_u32 v166, v1, 4, s75
L_tile2:
    global_load_dwordx4 v[32:35], v[2:3], off nt
    v_lshl_add_u64 v[2:3], v[2:3], 0, s[62:63]
    global_load_dwordx4 v[36:39], v[2:3], off nt
    v_lshl_add_u64 v[2:3], v[2:3], 0, s[62:63]
    global_load_dwordx4 v[40:43], v[2:3], off nt
    v_lshl_add_u64 v[2:3], v[2:3], 0, s[62:63]
    global_load_dwordx4 v[44:47], v[2:3], off nt
    v_lshl_add_u64 v[2:3], v[2:3], 0, s[62:63]
    global_load_dwordx4 v[48:51], v[2:3], off nt
    v_lshl_add_u64 v[2:3], v[2:3], 0, s[62:63]
    global_load_dwordx4 v[52:55], v[2:3], off nt
    v_lshl_add_u64 v[2:3], v[2:3], 0, s[62:63]
    global_load_dwordx4 v[56:59], v[2:3], off nt
    v_lshl_add_u64 v[2:3], v[2:3], 0, s[62:63]
    global_load_dwordx4 v[60:63], v[2:3], off nt
    v_lshl_add_u64 v[2:3], v[2:3], 0, s[62:63]
    v_perm_b32 v167, v8, v8, s64
    v_and_b32 v24, v167, v4
    v_and_b32 v25, v167, v5
    v_and_b32 v26, v167, v6
    v_and_b32 v27, v167, v7
    s_waitcnt vmcnt(7)
    s_nop 0
    v_mfma_f32_16x16x32_bf16 v[160:163], v[24:27], v[32:35], 0
    global_load_dwordx4 v[64:67], v[2:3], off nt
    v_lshl_add_u64 v[2:3], v[2:3], 0, s[62:63]
    v_perm_b32 v167, v8, v8, s65
    v_and_b32 v28, v167, v4
    v_and_b32 v29, v167, v5
    v_and_b32 v30, v167, v6
    v_and_b32 v31, v167, v7
    s_waitcnt vmcnt(7)
    s_nop 0
    v_mfma_f32_16x16x32_bf16 v[160:163], v[28:31], v[36:39], v[160:163]
    global_load_dwordx4 v[68:71], v[2:3], off nt
    v_lshl_add_u64 v[2:3], v[2:3], 0, s[62:63]
    v_perm_b32 v167, v9, v9, s64
    v_and_b32 v24, v167, v4
    v_and_b32 v25, v167, v5
    v_and_b32 v26, v167, v6
    v_and_b32 v27, v167, v7
    s_waitcnt vmcnt(7)
    s_nop 0
    v_mfma_f32_16x16x32_bf16 v[160:163], v[24:27], v[40:43], v[160:163]
    global_load_dwordx4 v[72:75], v[2:3], off nt
    v_lshl_add_u64 v[2:3], v[2:3], 0, s[62:63]
    v_perm_b32 v167, v9, v9, s65
    v_and_b32 v28, v167, v4
    v_and_b32 v29, v167, v5
    v_and_b32 v30, v167, v6
    v_and_b32 v31, v167, v7
    s_waitcnt vmcnt(7)
    s_nop 0
    v_mfma_f32_16x16x32_bf16 v[160:163], v[28:31], v[44:47], v[160:163]
    global_load_dwordx4 v[76:79], v[2:3], off nt
    v_lshl_add_u64 v[2:3], v[2:3], 0, s[62:63]
    v_perm_b32 v167, v10, v10, s64
    v_and_b32 v24, v167, v4
    v_and_b32 v25, v167, v5
    v_and_b32 v26, v167, v6
    v_and_b32 v27, v167, v7
    s_waitcnt vmcnt(7)
    s_nop 0
    v_mfma_f32_16x16x32_bf16 v[160:163], v[24:27], v[48:51], v[160:163]
    global_load_dwordx4 v[80:83], v[2:3], off nt
    v_lshl_add_u64 v[2:3], v[2:3], 0, s[62:63]
    v_perm_b32 v167, v10, v10, s65
    v_and_b32 v28, v167, v4
    v_and_b32 v29, v167, v5
    v_and_b32 v30, v167, v6
    v_and_b32 v31, v167, v7
    s_waitcnt vmcnt(7)
    s_nop 0
    v_mfma_f32_16x16x32_bf16 v[160:163], v[28:31], v[52:55], v[160:163]
    global_load_dwordx4 v[84:87], v[2:3], off nt
    v_lshl_add_u64 v[2:3], v[2:3], 0, s[62:63]
    v_perm_b32 v167, v11, v11, s64
    v_and_b32 v24, v167, v4
    v_and_b32 v25, v167, v5
    v_and_b32 v26, v167, v6
    v_and_b32 v27, v167, v7
    s_waitcnt vmcnt(7)
    s_nop 0
    v_mfma_f32_16x16x32_bf16 v[160:163], v[24:27], v[56:59], v[160:163]
    global_load_dwordx4 v[88:91], v[2:3], off nt
    v_lshl_add_u64 v[2:3], v[2:3], 0, s[62:63]
    v_perm_b32 v167, v11, v11, s65
    v_and_b32 v28, v167, v4
    v_and_b32 v29, v167, v5
    v_and_b32 v30, v167, v6
    v_and_b32 v31, v167, v7
    s_waitcnt vmcnt(7)
    s_nop 0
    v_mfma_f32_16x16x32_bf16 v[160:163], v[28:31], v[60:63], v[160:163]
    global_load_dwordx4 v[92:95], v[2:3], off nt
    v_lshl_add_u64 v[2:3], v[2:3], 0, s[62:63]
    v_perm_b32 v167, v12, v12, s64
    v_and_b32 v24, v167, v4
    v_and_b32 v25, v167, v5
    v_and_b32 v26, v167, v6
    v_and_b32 v27, v167, v7
    s_waitcnt vmcnt(7)
    s_nop 0
    v_mfma_f32_16x16x32_bf16 v[160:163], v[24:27], v[64:67], v[160:163]
    global_load_dwordx4 v[96:99], v[2:3], off nt
    v_lshl_add_u64 v[2:3], v[2:3], 0, s[62:63]
    v_perm_b32 v167, v12, v12, s65
    v_and_b32 v28, v167, v4
    v_and_b32 v29, v167, v5
    v_and_b32 v30, v167, v6
    v_and_b32 v31, v167, v7
    s_waitcnt vmcnt(7)
    s_nop 0
    v_mfma_f32_16x16x32_bf16 v[160:163], v[28:31], v[68:71], v[160:163]
    global_load_dwordx4 v[100:103], v[2:3], off nt
    v_lshl_add_u64 v[2:3], v[2:3], 0, s[62:63]
    v_perm_b32 v167, v13, v13, s64
    v_and_b32 v24, v167, v4
    v_and_b32 v25, v167, v5
    v_and_b32 v26, v167, v6
    v_and_b32 v27, v167, v7
    s_waitcnt vmcnt(7)
    s_nop 0
    v_mfma_f32_16x16x32_bf16 v[160:163], v[24:27], v[72:75], v[160:163]
    global_load_dwordx4 v[104:107], v[2:3], off nt
    v_lshl_add_u64 v[2:3], v[2:3], 0, s[62:63]
    v_perm_b32 v167, v13, v13, s65
    v_and_b32 v28, v167, v4
    v_and_b32 v29, v167, v5
    v_and_b32 v30, v167, v6
    v_and_b32 v31, v167, v7
    s_waitcnt vmcnt(7)
    s_nop 0
    v_mfma_f32_16x16x32_bf16 v[160:163], v[28:31], v[76:79], v[160:163]
    global_load_dwordx4 v[108:111], v[2:3], off nt
    v_lshl_add_u64 v[2:3], v[2:3], 0, s[62:63]
    v_perm_b32 v167, v14, v14, s64
    v_and_b32 v24, v167, v4
    v_and_b32 v25, v167, v5
    v_and_b32 v26, v167, v6
    v_and_b32 v27, v167, v7
    s_waitcnt vmcnt(7)
    s_nop 0
    v_mfma_f32_16x16x32_bf16 v[160:163], v[24:27], v[80:83], v[160:163]
    global_load_dwordx4 v[112:115], v[2:3], off nt
    v_lshl_add_u64 v[2:3], v[2:3], 0, s[62:63]
    v_perm_b32 v167, v14, v14, s65
    v_and_b32 v28, v167, v4
    v_and_b32 v29, v167, v5
    v_and_b32 v30, v167, v6
    v_and_b32 v31, v167, v7
    s_waitcnt vmcnt(7)
    s_nop 0
    v_mfma_f32_16x16x32_bf16 v[160:163], v[28:31], v[84:87], v[160:163]
    global_load_dwordx4 v[116:119], v[2:3], off nt
    v_lshl_add_u64 v[2:3], v[2:3], 0, s[62:63]
    v_perm_b32 v167, v15, v15, s64
    v_and_b32 v24, v167, v4
    v_and_b32 v25, v167, v5
    v_and_b32 v26, v167, v6
    v_and_b32 v27, v167, v7
    s_waitcnt vmcnt(7)
    s_nop 0
    v_mfma_f32_16x16x32_bf16 v[160:163], v[24:27], v[88:91], v[160:163]
    global_load_dwordx4 v[120:123], v[2:3], off nt
    v_lshl_add_u64 v[2:3], v[2:3], 0, s[62:63]
    v_perm_b32 v167, v15, v15, s65
    v_and_b32 v28, v167, v4
    v_and_b32 v29, v167, v5
    v_and_b32 v30, v167, v6
    v_and_b32 v31, v167, v7
    s_waitcnt vmcnt(7)
    s_nop 0
    v_mfma_f32_16x16x32_bf16 v[160:163], v[28:31], v[92:95], v[160:163]
    global_load_dwordx4 v[124:127], v[2:3], off nt
    v_lshl_add_u64 v[2:3], v[2:3], 0, s[62:63]
    v_perm_b32 v167, v16, v16, s64
    v_and_b32 v24, v167, v4
    v_and_b32 v25, v167, v5
    v_and_b32 v26, v167, v6
    v_and_b32 v27, v167, v7
    s_waitcnt vmcnt(7)
    s_nop 0
    v_mfma_f32_16x16x32_bf16 v[160:163], v[24:27], v[96:99], v[160:163]
    global_load_dwordx4 v[128:131], v[2:3], off nt
    v_lshl_add_u64 v[2:3], v[2:3], 0, s[62:63]
    v_perm_b32 v167, v16, v16, s65
    v_and_b32 v28, v167, v4
    v_and_b32 v29, v167, v5
    v_and_b32 v30, v167, v6
    v_and_b32 v31, v167, v7
    s_waitcnt vmcnt(7)
    s_nop 0
    v_mfma_f32_16x16x32_bf16 v[160:163], v[28:31], v[100:103], v[160:163]
    global_load_dwordx4 v[132:135], v[2:3], off nt
    v_lshl_add_u64 v[2:3], v[2:3], 0, s[62:63]
    v_perm_b32 v167, v17, v17, s64
    v_and_b32 v24, v167, v4
    v_and_b32 v25, v167, v5
    v_and_b32 v26, v167, v6
    v_and_b32 v27, v167, v7
    s_waitcnt vmcnt(7)
    s_nop 0
    v_mfma_f32_16x16x32_bf16 v[160:163], v[24:27], v[104:107], v[160:163]
    global_load_dwordx4 v[136:139], v[2:3], off nt
    v_lshl_add_u64 v[2:3], v[2:3], 0, s[62:63]
    v_perm_b32 v167, v17, v17, s65
    v_and_b32 v28, v167, v4
    v_and_b32 v29, v167, v5
    v_and_b32 v30, v167, v6
    v_and_b32 v31, v167, v7
    s_waitcnt vmcnt(7)
    s_nop 0
    v_mfma_f32_16x16x32_bf16 v[160:163], v[28:31], v[108:111], v[160:163]
    global_load_dwordx4 v[140:143], v[2:3], off nt
    v_lshl_add_u64 v[2:3], v[2:3], 0, s[62:63]
    v_perm_b32 v167, v18, v18, s64
    v_and_b32 v24, v167, v4
    v_and_b32 v25, v167, v5
    v_and_b32 v26, v167, v6
    v_and_b32 v27, v167, v7
    s_waitcnt vmcnt(7)
    s_nop 0
    v_mfma_f32_16x16x32_bf16 v[160:163], v[24:27], v[112:115], v[160:163]
    global_load_dwordx4 v[144:147], v[2:3], off nt
    v_lshl_add_u64 v[2:3], v[2:3], 0, s[62:63]
    v_perm_b32 v167, v18, v18, s65
    v_and_b32 v28, v167, v4
    v_and_b32 v29, v167, v5
    v_and_b32 v30, v167, v6
    v_and_b32 v31, v167, v7
    s_waitcnt vmcnt(7)
    s_nop 0
    v_mfma_f32_16x16x32_bf16 v[160:163], v[28:31], v[116:119], v[160:163]
    global_load_dwordx4 v[148:151], v[2:3], off nt
    v_lshl_add_u64 v[2:3], v[2:3], 0, s[62:63]
    v_perm_b32 v167, v19, v19, s64
    v_and_b32 v24, v167, v4
    v_and_b32 v25, v167, v5
    v_and_b32 v26, v167, v6
    v_and_b32 v27, v167, v7
    s_waitcnt vmcnt(7)
    s_nop 0
    v_mfma_f32_16x16x32_bf16 v[160:163], v[24:27], v[120:123], v[160:163]
    global_load_dwordx4 v[152:155], v[2:3], off nt
    v_lshl_add_u64 v[2:3], v[2:3], 0, s[62:63]
    v_perm_b32 v167, v19, v19, s65
    v_and_b32 v28, v167, v4
    v_and_b32 v29, v167, v5
    v_and_b32 v30, v167, v6
    v_and_b32 v31, v167, v7
    s_waitcnt vmcnt(7)
    s_nop 0
    v_mfma_f32_16x16x32_bf16 v[160:163], v[28:31], v[124:127], v[160:163]
    global_load_dwordx4 v[156:159], v[2:3], off nt
    v_perm_b32 v167, v20, v20, s64
    v_and_b32 v24, v167, v4
    v_and_b32 v25, v167, v5
    v_and_b32 v26, v167, v6
    v_and_b32 v27, v167, v7
    s_waitcnt vmcnt(7)
    s_nop 0
    v_mfma_f32_16x16x32_bf16 v[160:163], v[24:27], v[128:131], v[160:163]
    v_perm_b32 v167, v20, v20, s65
    v_and_b32 v28, v167, v4
    v_and_b32 v29, v167, v5
    v_and_b32 v30, v167, v6
    v_and_b32 v31, v167, v7
    s_waitcnt vmcnt(6)
    s_nop 0
    v_mfma_f32_16x16x32_bf16 v[160:163], v[28:31], v[132:135], v[160:163]
    v_perm_b32 v167, v21, v21, s64
    v_and_b32 v24, v167, v4
    v_and_b32 v25, v167, v5
    v_and_b32 v26, v167, v6
    v_and_b32 v27, v167, v7
    s_waitcnt vmcnt(5)
    s_nop 0
    v_mfma_f32_16x16x32_bf16 v[160:163], v[24:27], v[136:139], v[160:163]
    v_perm_b32 v167, v21, v21, s65
    v_and_b32 v28, v167, v4
    v_and_b32 v29, v167, v5
    v_and_b32 v30, v167, v6
    v_and_b32 v31, v167, v7
    s_waitcnt vmcnt(4)
    s_nop 0
    v_mfma_f32_16x16x32_bf16 v[160:163], v[28:31], v[140:143], v[160:163]
    v_perm_b32 v167, v22, v22, s64
    v_and_b32 v24, v167, v4
    v_and_b32 v25, v167, v5
    v_and_b32 v26, v167, v6
    v_and_b32 v27, v167, v7
    s_waitcnt vmcnt(3)
    s_nop 0
    v_mfma_f32_16x16x32_bf16 v[160:163], v[24:27], v[144:147], v[160:163]
    v_perm_b32 v167, v22, v22, s65
    v_and_b32 v28, v167, v4
    v_and_b32 v29, v167, v5
    v_and_b32 v30, v167, v6
    v_and_b32 v31, v167, v7
    s_waitcnt vmcnt(2)
    s_nop 0
    v_mfma_f32_16x16x32_bf16 v[160:163], v[28:31], v[148:151], v[160:163]
    v_perm_b32 v167, v23, v23, s64
    v_and_b32 v24, v167, v4
    v_and_b32 v25, v167, v5
    v_and_b32 v26, v167, v6
    v_and_b32 v27, v167, v7
    s_waitcnt vmcnt(1)
    s_nop 0
    v_mfma_f32_16x16x32_bf16 v[160:163], v[24:27], v[152:155], v[160:163]
    v_perm_b32 v167, v23, v23, s65
    v_and_b32 v28, v167, v4
    v_and_b32 v29, v167, v5
    v_and_b32 v30, v167, v6
    v_and_b32 v31, v167, v7
    s_waitcnt vmcnt(0)
    s_nop 0
    v_mfma_f32_16x16x32_bf16 v[160:163], v[28:31], v[156:159], v[160:163]
    v_mov_b32 v165, 511
    s_nop 7
    v_add_u32 v160, 256, v160
    v_add_u32 v161, 256, v161
    v_add_u32 v162, 256, v162
    v_add_u32 v163, 256, v163
    v_bfi_b32 v160, v165, s80, v160
    v_bfi_b32 v161, v165, s0, v161
    v_bfi_b32 v162, v165, s1, v162
    v_bfi_b32 v163, v165, s14, v163
    global_store_dwordx4 v166, v[160:163], s[26:27] sc1
    s_cmp_lt_u32 s96, 120
    s_cbranch_scc1 L_wo
L_ffn_done:
    s_cmp_ge_u32 s59, 80
    s_cbranch_scc1 L_c_done
    s_cmp_ge_u32 s59, 40
    s_cselect_b32 s78, 1, 0
    s_mul_i32 s47, s78, 40
    s_sub_u32 s77, s59, s47
    s_lshr_b32 s47, s77, 3
    s_lshl_b32 s47, s47, 10
    s_and_b32 s48, s77, 7
    s_lshl_b32 s48, s48, 6
    s_add_u32 s47, s47, s48
    s_lshl_b32 s48, s78, 9
    s_add_u32 s47, s47, s48
    s_add_u32 s47, s47, 589824
    v_lshrrev_b32 v164, 2, v1
    v_mul_u32_u24 v164, 5120, v164
    v_and_b32 v165, 3, v1
    v_lshl_add_u32 v164, v165, 4, v164
    v_add_u32 v16, s47, v164
    v_add_u32 v17, 81920, v16
    v_add_u32 v18, 81920, v17
    v_add_u32 v164, 81920, v18
    s_mul_i32 s47, s78, 1280
    s_lshl_b32 s48, s77, 5
    s_add_u32 s47, s47, s48
    v_lshl_add_u32 v19, v165, 3, s47
    v_bfe_u32 v165, v1, 4, 1
    v_lshl_add_u32 v19, v165, 2, v19
    v_lshrrev_b32 v165, 5, v1
    v_lshl_add_u32 v19, v165, 1, v19
    global_load_ushort v12, v19, s[4:5]
    v_mov_b32 v8, 0
    v_mov_b32 v9, 0
    v_mov_b32 v10, 0
    v_mov_b32 v11, 0
    s_bfm_b64 exec, 48, 0
L_pollF:
    s_sleep 48
    global_load_dwordx4 v[8:11], v164, s[26:27] sc1
    s_waitcnt vmcnt(0)
    v_xor_b32 v8, s80, v8
    v_xor_b32 v9, s0, v9
    v_xor_b32 v10, s1, v10
    v_xor_b32 v11, s14, v11
    v_or_b32 v166, v8, v9
    v_or3_b32 v166, v166, v10, v11
    v_and_b32 v166, 511, v166
    v_cmp_ne_u32 vcc, 0, v166
    s_cbranch_vccz L_gotF
    s_sub_u32 s58, s58, 1
    s_cmp_gt_i32 s58, 0
    s_cbranch_scc1 L_pollF
L_gotF:
    s_mov_b64 exec, -1
    s_nop 1
    v_permlane32_swap_b32 v8, v9
    v_permlane32_swap_b32 v10, v11
    s_nop 0
    v_add_f32 v8, v8, v9
    v_add_f32 v10, v10, v11
    s_nop 1
    v_permlane16_swap_b32 v8, v10
    s_nop 0
    v_add_f32 v8, v8, v10
    s_nop 1
    v_add_f32_dpp v8, v8, v8 row_ror:4 row_mask:0xf bank_mask:0xf
    s_nop 1
    v_add_f32_dpp v8, v8, v8 row_ror:8 row_mask:0xf bank_mask:0xf
    v_lshlrev_b32 v12, 16, v12
    v_cvt_pk_bf16_f32 v8, v8, v8
    v_and_b32 v8, 0xffff0000, v8
    v_mul_f32 v167, 0xbfb8aa3b, v8
    v_exp_f32 v167, v167
    s_nop 0
    v_add_f32 v167, 1.0, v167
    v_rcp_f32 v167, v167
    s_nop 0
    v_mul_f32 v8, v8, v167
    v_cvt_pk_bf16_f32 v8, v8, v8
    v_and_b32 v8, 0xffff0000, v8
L_c_done:
    v_lshrrev_b32 v20, 4, v1
    v_lshlrev_b32 v20, 10, v20
    v_bfe_u32 v164, v1, 1, 3
    v_lshl_add_u32 v20, v164, 4, v20
    v_and_b32 v164, 1, v1
    v_lshl_add_u32 v20, v164, 8, v20
    v_mov_b32 v21, 0
    v_lshl_add_u32 v22, v1, 4, s68
    v_mov_b32 v23, 511
    v_cmp_eq_u32 s[50:51], 48, v1
    v_and_b32 v2, 15, v1
    v_lshlrev_b32 v2, 5, v2
    v_and_b32 v165, 16, v1
    v_add_u32 v2, v2, v165
    v_and_b32 v165, 32, v1
    v_lshl_add_u32 v2, v165, 4, v2
    v_add_u32 v2, s74, v2
    v_lshlrev_b32 v160, 4, v1
    s_setprio 3
    s_mov_b64 exec, 0
    s_branch WT_0
L_wt_ret:
    s_mov_b64 exec, -1
    s_branch L_wt_go
L_wt_go:
WT_0:
    s_cbranch_execz WT_p1
    s_barrier
    ds_read_b128 v[24:27], v21 offset:960
    ds_read_b128 v[28:31], v21 offset:976
    ds_read_b128 v[32:35], v20 offset:5120
    ds_read_b128 v[36:39], v20 offset:5760
    ds_read_b128 v[40:43], v20 offset:8192
    ds_read_b128 v[44:47], v20 offset:8832
    ds_read_b128 v[48:51], v20 offset:11264
    ds_read_b128 v[52:55], v20 offset:11904
    ds_read_b128 v[56:59], v20 offset:14336
    ds_read_b128 v[60:63], v20 offset:14976
    s_waitcnt lgkmcnt(8)
    v_max_f32 v164, v24, v26
    v_max3_f32 v164, v164, v28, v30
    v_and_b32 v164, s81, v164
    v_sub_f32 v24, v24, v164
    v_sub_f32 v26, v26, v164
    v_sub_f32 v28, v28, v164
    v_sub_f32 v30, v30, v164
    v_exp_f32 v24, v24
    v_exp_f32 v26, v26
    v_exp_f32 v28, v28
    v_exp_f32 v30, v30
    s_nop 0
    v_mul_f32 v165, v24, v25
    v_fmac_f32 v165, v26, v27
    v_fmac_f32 v165, v28, v29
    v_fmac_f32 v165, v30, v31
    s_waitcnt lgkmcnt(6)
    v_pk_add_f32 v[32:33], v[32:33], v[36:37]
    v_pk_add_f32 v[34:35], v[34:35], v[38:39]
    v_pk_mul_f32 v[64:65], v[24:25], v[32:33] op_sel_hi:[0,1]
    v_pk_mul_f32 v[66:67], v[24:25], v[34:35] op_sel_hi:[0,1]
WT_p1:
    s_cbranch_execz WT_p2
    s_waitcnt lgkmcnt(4)
    v_pk_add_f32 v[40:41], v[40:41], v[44:45]
    v_pk_add_f32 v[42:43], v[42:43], v[46:47]
    v_pk_fma_f32 v[64:65], v[26:27], v[40:41], v[64:65] op_sel_hi:[0,1,1]
    v_pk_fma_f32 v[66:67], v[26:27], v[42:43], v[66:67] op_sel_hi:[0,1,1]
    s_waitcnt lgkmcnt(2)
    v_pk_add_f32 v[48:49], v[48:49], v[52:53]
    v_pk_add_f32 v[50:51], v[50:51], v[54:55]
    v_pk_fma_f32 v[64:65], v[28:29], v[48:49], v[64:65] op_sel_hi:[0,1,1]
    v_pk_fma_f32 v[66:67], v[28:29], v[50:51], v[66:67] op_sel_hi:[0,1,1]
    s_waitcnt lgkmcnt(0)
    v_pk_add_f32 v[56:57], v[56:57], v[60:61]
    v_pk_add_f32 v[58:59], v[58:59], v[62:63]
    v_pk_fma_f32 v[64:65], v[30:31], v[56:57], v[64:65] op_sel_hi:[0,1,1]
    v_pk_fma_f32 v[66:67], v[30:31], v[58:59], v[66:67] op_sel_hi:[0,1,1]
    v_cndmask_b32 v64, v64, v164, s[50:51]
    v_cndmask_b32 v65, v65, v165, s[50:51]
    v_add_u32 v64, 256, v64
    v_add_u32 v65, 256, v65
    v_add_u32 v66, 256, v66
    v_add_u32 v67, 256, v67
    v_bfi_b32 v64, v23, s80, v64
    v_bfi_b32 v65, v23, s0, v65
    v_bfi_b32 v66, v23, s1, v66
    v_bfi_b32 v67, v23, s14, v67
    s_bfm_b64 exec, 49, 0
WT_p2:
    s_cbranch_execz WT_p3
    global_store_dwordx4 v22, v[64:67], s[26:27]
    global_store_dwordx4 v22, v[64:67], s[90:91] sc1
    s_mov_b64 exec, -1
    s_cmp_lg_u32 s83, 0
    s_cbranch_scc1 L_noy
    s_barrier
    ds_read_b128 v[32:35], v160 offset:1024
    ds_read_b128 v[36:39], v160 offset:2048
    ds_read_b128 v[40:43], v160 offset:3072
    ds_read_b128 v[44:47], v160 offset:4096
    s_waitcnt lgkmcnt(2)
    v_pk_add_f32 v[32:33], v[32:33], v[36:37]
    v_pk_add_f32 v[34:35], v[34:35], v[38:39]
    s_waitcnt lgkmcnt(1)
    v_pk_add_f32 v[32:33], v[32:33], v[40:41]
    v_pk_add_f32 v[34:35], v[34:35], v[42:43]
    s_waitcnt lgkmcnt(0)
    v_pk_add_f32 v[32:33], v[32:33], v[44:45]
    v_pk_add_f32 v[34:35], v[34:35], v[46:47]
    v_add_u32 v32, 256, v32
    v_add_u32 v33, 256, v33
    v_add_u32 v34, 256, v34
    v_add_u32 v35, 256, v35
    v_bfi_b32 v32, v23, s80, v32
    v_bfi_b32 v33, v23, s0, v33
    v_bfi_b32 v34, v23, s1, v34
    v_bfi_b32 v35, v23, s14, v35
WT_p3:
    s_cbranch_execz WT_p4
    global_store_dwordx4 v2, v[32:35], s[26:27] sc1
L_noy:
    s_cmp_ge_u32 s59, 80
    s_cbranch_scc1 L_adone
    global_load_dwordx4 v[48:51], v16, s[26:27] sc1
    global_load_dwordx4 v[52:55], v17, s[26:27] sc1
    global_load_dwordx4 v[56:59], v18, s[26:27] sc1
    s_sleep 5
    global_load_dwordx4 v[60:63], v16, s[26:27] sc1
    global_load_dwordx4 v[64:67], v17, s[26:27] sc1
    global_load_dwordx4 v[68:71], v18, s[26:27] sc1
    s_sleep 5
L_pollY:
    global_load_dwordx4 v[72:75], v16, s[26:27] sc1
    global_load_dwordx4 v[76:79], v17, s[26:27] sc1
    global_load_dwordx4 v[80:83], v18, s[26:27] sc1
    s_waitcnt vmcnt(6)
    v_xor_b32 v48, s80, v48
    v_xor_b32 v49, s0, v49
    v_xor_b32 v50, s1, v50
    v_xor_b32 v51, s14, v51
    v_xor_b32 v52, s80, v52
    v_xor_b32 v53, s0, v53
    v_xor_b32 v54, s1, v54
    v_xor_b32 v55, s14, v55
    v_xor_b32 v56, s80, v56
    v_xor_b32 v57, s0, v57
    v_xor_b32 v58, s1, v58
    v_xor_b32 v59, s14, v59
    v_or_b32 v166, v48, v49
    v_or3_b32 v166, v166, v50, v51
    v_or3_b32 v166, v166, v52, v53
    v_or3_b32 v166, v166, v54, v55
    v_or3_b32 v166, v166, v56, v57
WT_p4:
    s_cbranch_execz WT_p5
    v_or3_b32 v166, v166, v58, v59
    v_and_b32 v166, 511, v166
    v_cmp_ne_u32 vcc, 0, v166
    s_cbranch_vccz L_gotY0
    global_load_dwordx4 v[48:51], v16, s[26:27] sc1
    global_load_dwordx4 v[52:55], v17, s[26:27] sc1
    global_load_dwordx4 v[56:59], v18, s[26:27] sc1
    s_waitcnt vmcnt(6)
    v_xor_b32 v60, s80, v60
    v_xor_b32 v61, s0, v61
    v_xor_b32 v62, s1, v62
    v_xor_b32 v63, s14, v63
    v_xor_b32 v64, s80, v64
    v_xor_b32 v65, s0, v65
    v_xor_b32 v66, s1, v66
    v_xor_b32 v67, s14, v67
    v_xor_b32 v68, s80, v68
    v_xor_b32 v69, s0, v69
    v_xor_b32 v70, s1, v70
    v_xor_b32 v71, s14, v71
    v_or_b32 v166, v60, v61
    v_or3_b32 v166, v166, v62, v63
    v_or3_b32 v166, v166, v64, v65
    v_or3_b32 v166, v166, v66, v67
    v_or3_b32 v166, v166, v68, v69
    v_or3_b32 v166, v166, v70, v71
    v_and_b32 v166, 511, v166
    v_cmp_ne_u32 vcc, 0, v166
    s_cbranch_vccz L_gotY1
    global_load_dwordx4 v[60:63], v16, s[26:27] sc1
    global_load_dwordx4 v[64:67], v17, s[26:27] sc1
    global_load_dwordx4 v[68:71], v18, s[26:27] sc1
    s_waitcnt vmcnt(6)
    v_xor_b32 v72, s80, v72
WT_p5:
    s_cbranch_execz WT_p6
    v_xor_b32 v73, s0, v73
    v_xor_b32 v74, s1, v74
    v_xor_b32 v75, s14, v75
    v_xor_b32 v76, s80, v76
    v_xor_b32 v77, s0, v77
    v_xor_b32 v78, s1, v78
    v_xor_b32 v79, s14, v79
    v_xor_b32 v80, s80, v80
    v_xor_b32 v81, s0, v81
    v_xor_b32 v82, s1, v82
    v_xor_b32 v83, s14, v83
    v_or_b32 v166, v72, v73
    v_or3_b32 v166, v166, v74, v75
    v_or3_b32 v166, v166, v76, v77
    v_or3_b32 v166, v166, v78, v79
    v_or3_b32 v166, v166, v80, v81
    v_or3_b32 v166, v166, v82, v83
    v_and_b32 v166, 511, v166
    v_cmp_ne_u32 vcc, 0, v166
    s_cbranch_vccz L_gotY2
    s_sub_u32 s58, s58, 1
    s_cmp_gt_i32 s58, 0
    s_cbranch_scc1 L_pollY
L_gotY2:
    v_pk_add_f32 v[164:165], v[72:73], v[76:77]
    v_pk_add_f32 v[166:167], v[74:75], v[78:79]
    v_pk_add_f32 v[164:165], v[164:165], v[80:81]
    v_pk_add_f32 v[166:167], v[166:167], v[82:83]
    s_branch L_gotY
L_gotY1:
    v_pk_add_f32 v[164:165], v[60:61], v[64:65]
    v_pk_add_f32 v[166:167], v[62:63], v[66:67]
    v_pk_add_f32 v[164:165], v[164:165], v[68:69]
    v_pk_add_f32 v[166:167], v[166:167], v[70:71]
    s_branch L_gotY
L_gotY0:
WT_p6:
    s_cbranch_execz WT_p7
    v_pk_add_f32 v[164:165], v[48:49], v[52:53]
    v_pk_add_f32 v[166:167], v[50:51], v[54:55]
    v_pk_add_f32 v[164:165], v[164:165], v[56:57]
    v_pk_add_f32 v[166:167], v[166:167], v[58:59]
L_gotY:
    s_nop 1
    v_permlane32_swap_b32 v164, v165
    v_permlane32_swap_b32 v166, v167
    s_nop 0
    v_add_f32 v164, v164, v165
    v_add_f32 v166, v166, v167
    s_nop 1
    v_permlane16_swap_b32 v164, v166
    s_nop 0
    v_add_f32 v164, v164, v166
    s_nop 1
    v_add_f32_dpp v164, v164, v164 row_ror:4 row_mask:0xf bank_mask:0xf
    s_nop 1
    v_add_f32_dpp v164, v164, v164 row_ror:8 row_mask:0xf bank_mask:0xf
    v_cvt_pk_bf16_f32 v164, v164, v164
    v_and_b32 v164, 0xffff0000, v164
    v_mul_f32 v164, v164, v8
    v_cvt_pk_bf16_f32 v164, v164, v164
    v_and_b32 v164, 0xffff0000, v164
    v_add_f32 v164, v164, v12
    s_mov_b32 exec_lo, 0x000f000f
    s_mov_b32 exec_hi, 0x000f000f
    v_cvt_pk_bf16_f32 v164, v164, v164
    global_store_short v19, v164, s[22:23]
    s_cmp_lg_u32 s59, 79
    s_cbranch_scc1 L_adone
    s_mov_b64 exec, 1
    v_mov_b32 v166, 323584
WT_p7:
    s_cbranch_execz L_wt_ret
    v_mov_b32 v165, s82
    global_store_dword v166, v165, s[26:27]
L_adone:
    s_mov_b64 exec, -1
L_end:
    s_endpgm
.section .rodata,"a"
.p2align 6
.amdhsa_kernel recurrent_scan__gqa_block_cached__geglu_ffn__decode_kernel
  .amdhsa_next_free_vgpr 168
  .amdhsa_next_free_sgpr 102
  .amdhsa_accum_offset 168
  .amdhsa_group_segment_fixed_size 0
  .amdhsa_kernarg_size 96
  .amdhsa_user_sgpr_count 2
  .amdhsa_user_sgpr_kernarg_segment_ptr 1
  .amdhsa_system_sgpr_workgroup_id_x 1
  .amdhsa_float_denorm_mode_32 3
.end_amdhsa_kernel
```
